```python
import torch

def _softmax(x, axis=-1):
    return torch.softmax(x, dim=axis)
def _gelu(x):
    return torch.nn.functional.gelu(x, approximate="tanh")
def _silu(x):
    return torch.nn.functional.silu(x)
def _sigmoid(x):
    return torch.sigmoid(x)
def _layernorm(x, axis=-1, eps=1e-5):
    m = x.mean(dim=axis, keepdim=True)
    v = x.var(dim=axis, keepdim=True, unbiased=False)
    return (x - m) / torch.sqrt(v + eps)
def _scatter_add(tgt, idx, src, axis=0):
    return tgt.clone().index_add_(axis, idx, src)
def _segment_sum(src, seg, n):
    out = torch.zeros((n,) + src.shape[1:], dtype=src.dtype)
    return out.index_add_(0, seg, src)
def _pad(x, pw):
    flat = tuple(v for pair in reversed(pw) for v in pair)
    return torch.nn.functional.pad(x, flat)

kernel_name = 'parallel_sum__grouped_kv_mqa__dense_activation_mish__prompt'

def setup_inputs():

    _w = (lambda a: (lambda t: t.to(torch.bfloat16) if t.is_floating_point() else t)(torch.as_tensor(a)))
    def _A_setup():
        B, S, D, H = 1, 2048, 512, 32
        Dh = D // H
        return {
            "x": _w((lambda *s: torch.randn(*s, dtype=torch.bfloat16) * 0.05)(B, S, D)),
            "wq": _w((lambda *s: torch.randn(*s, dtype=torch.bfloat16) * 0.05)(D, H * Dh)),
            "wk": _w((lambda *s: torch.randn(*s, dtype=torch.bfloat16) * 0.05)(D, Dh)),
            "wv": _w((lambda *s: torch.randn(*s, dtype=torch.bfloat16) * 0.05)(D, Dh)),
            "wo": _w((lambda *s: torch.randn(*s, dtype=torch.bfloat16) * 0.05)(H * Dh, D)),
        }
    _A_in = _A_setup()

    def _B_setup():
        B, S, D, F = 1, 2048, 512, 1376
        return {
            "x": _w((lambda *s: torch.randn(*s, dtype=torch.bfloat16) * 0.05)(B, S, D)),
            "w1": _w((lambda *s: torch.randn(*s, dtype=torch.bfloat16) * 0.8)(D, F) * (D ** -0.5)),
            "b1": _w((lambda *s: torch.randn(*s, dtype=torch.bfloat16) * 0.4)(F)),
            "w2": _w((lambda *s: torch.randn(*s, dtype=torch.bfloat16) * 0.4)(F, D) * (F ** -0.5)),
        }
    _B_in = _B_setup()

    return {
        "A_x": _A_in["x"],
        "A_wq": _A_in["wq"],
        "A_wk": _A_in["wk"],
        "A_wv": _A_in["wv"],
        "A_wo": _A_in["wo"],
        "B_x": _B_in["x"],
        "B_w1": _B_in["w1"],
        "B_b1": _B_in["b1"],
        "B_w2": _B_in["w2"],
    }

def reference(A_x, A_wq, A_wk, A_wv, A_wo, B_x, B_w1, B_b1, B_w2):
    def _A_ref(x, wq, wk, wv, wo):
        B, S, D = x.shape
        H = 32
        Dh = D // H
        q = (lambda x, *d: x.permute(*d))((x @ wq).reshape(B, S, H, Dh), 0, 2, 1, 3)
        k = x @ wk
        v = x @ wv
        scores = torch.einsum("bhqd,bkd->bhqk", q, k) * (Dh ** -0.5)
        p = _softmax(scores, axis=-1)
        o = torch.einsum("bhqk,bkd->bhqd", p, v)
        return (lambda x, *d: x.permute(*d))(o, 0, 2, 1, 3).reshape(B, S, H * Dh) @ wo

    def _B_ref(x, w1, b1, w2):
        h = torch.einsum("bsd,df->bsf", x, w1) + b1
        sp = torch.log1p(torch.exp(-torch.abs(h))) + torch.where(h > 0, h, torch.zeros_like(h))
        act = h * torch.tanh(sp)
        return torch.einsum("bsf,fd->bsd", act, w2)

    x = A_x
    xn = _layernorm(x, axis=-1)
    return x + _A_ref(xn, A_wq, A_wk, A_wv, A_wo) + _B_ref(xn, B_w1, B_b1, B_w2)
```

```asm
; @launch grid=(256,1,1) block=(512,1,1) lds=163840
.amdgcn_target "amdgcn-amd-amdhsa--gfx950"
.text
.globl parallel_sum__grouped_kv_mqa__dense_activation_mish__prompt_kernel
.p2align 8
.type parallel_sum__grouped_kv_mqa__dense_activation_mish__prompt_kernel,@function
parallel_sum__grouped_kv_mqa__dense_activation_mish__prompt_kernel:
    s_cmp_ge_u32 s2, 256
    s_cbranch_scc1 L_done
    s_load_dwordx8 s[32:39], s[0:1], 0
    s_lshr_b32 s7, s2, 3
    s_getpc_b64 s[10:11]
L_pc:
    v_lshl_add_u32 v8, v0, 5, s7
    v_lshlrev_b32 v8, 7, v8
    v_cmp_gt_u32 vcc, L_slow - L_pc, v8
    v_mov_b32 v9, s11
    s_and_saveexec_b64 s[58:59], vcc
    s_cbranch_execz L_nocpf
    v_add_co_u32 v8, vcc, s10, v8
    s_nop 1
    v_addc_co_u32 v9, vcc, 0, v9, vcc
    global_load_dword v247, v[8:9], off
L_nocpf:
    s_mov_b64 exec, s[58:59]
    v_lshrrev_b32 v2, 6, v0
    v_and_b32 v1, 63, v0
    s_and_b32 s6, s2, 7
    v_readfirstlane_b32 s3, v2
    s_and_b32 s4, s7, 7
    s_lshl_b32 s4, s4, 2
    s_and_b32 s5, s6, 3
    s_add_u32 s4, s4, s5
    s_lshr_b32 s5, s7, 3
    s_lshl_b32 s5, s5, 1
    s_lshr_b32 s6, s6, 2
    s_add_u32 s5, s5, s6
    s_and_b32 s29, s5, 6
    s_add_u32 s29, s29, s3
    s_and_b32 s29, s29, 7
    s_lshl_b32 s6, s4, 6
    s_lshl_b32 s7, s29, 3
    s_add_u32 s6, s6, s7
    v_lshrrev_b32 v9, 3, v1
    v_add_u32 v2, s6, v9
    v_lshlrev_b32 v2, 10, v2
    v_and_b32 v8, 7, v1
    v_lshl_add_u32 v2, v8, 4, v2
    s_mov_b32 s10, 2097152
    s_mov_b32 s11, 0x00020000
    s_waitcnt lgkmcnt(0)
    s_mov_b32 s8, s32
    s_mov_b32 s9, s33
    buffer_load_dwordx4 v[24:27], v2, s[8:11], 0 offen offset:0
    buffer_load_dwordx4 v[28:31], v2, s[8:11], 0 offen offset:128
    buffer_load_dwordx4 v[32:35], v2, s[8:11], 0 offen offset:256
    buffer_load_dwordx4 v[36:39], v2, s[8:11], 0 offen offset:384
    buffer_load_dwordx4 v[40:43], v2, s[8:11], 0 offen offset:512
    buffer_load_dwordx4 v[44:47], v2, s[8:11], 0 offen offset:640
    buffer_load_dwordx4 v[48:51], v2, s[8:11], 0 offen offset:768
    buffer_load_dwordx4 v[52:55], v2, s[8:11], 0 offen offset:896
    s_load_dwordx2 s[40:41], s[0:1], 32
    s_load_dwordx8 s[44:51], s[0:1], 48
    s_load_dwordx2 s[54:55], s[0:1], 88
    v_add_u32 v9, s7, v9
    v_and_b32 v7, 31, v9
    v_lshlrev_b32 v7, 4, v7
    v_mul_u32_u24 v8, 528, v8
    v_add_u32 v7, v7, v8
    s_lshr_b32 s6, s29, 2
    s_mul_i32 s6, s6, 33792
    s_add_u32 s6, s6, 32768
    v_add_u32 v7, s6, v7
    v_lshlrev_b32 v23, 2, v9
    v_add_u32 v23, 159744, v23
    v_lshlrev_b32 v4, 4, v1
    s_mul_i32 s6, s5, 6
    s_mul_i32 s7, s5, 5
    s_add_u32 s7, s7, 3
    s_min_u32 s85, s6, s7
    s_cmp_lt_u32 s5, 3
    s_cselect_b32 s30, 6, 5
    s_lshr_b32 s6, s3, 1
    s_sub_u32 s86, s3, 2
    s_cmp_lt_u32 s3, 4
    s_cselect_b32 s24, 0, 1
    s_cselect_b32 s86, s6, s86
    s_add_u32 s28, s85, s86
    s_cmp_lt_u32 s86, s30
    s_cbranch_scc1 L_role
    s_cmp_eq_u32 s5, 3
    s_cselect_b32 s24, 3, 2
    s_sub_u32 s28, s5, 4
L_role:
    s_and_b32 s6, s3, 1
    s_lshl_b32 s7, s4, 1
    s_add_u32 s69, s6, s7
    s_lshl_b32 s6, s69, 5
    s_lshl_b32 s7, s5, 2
    s_add_u32 s6, s6, s7
    s_and_b32 s7, s3, 2
    s_add_u32 s6, s6, s7
    s_lshr_b32 s7, s3, 2
    s_add_u32 s6, s6, s7
    s_lshl_b32 s6, s6, 10
    s_add_u32 s68, s6, 3145728
    s_waitcnt lgkmcnt(0)
    s_mov_b32 s20, s54
    s_mov_b32 s21, s55
    s_mov_b32 s22, 16777216
    s_mov_b32 s23, 0x00020000
    s_load_dword s56, s[54:55], 524288
    s_cmp_lt_u32 s3, 2
    s_cselect_b32 s12, s34, s44
    s_cselect_b32 s13, s35, s45
    s_mov_b32 s14, 1409024
    s_cselect_b32 s14, 524288, s14
    s_mov_b32 s26, 2752
    s_cselect_b32 s26, 1024, s26
    s_mov_b32 s16, s46
    s_mov_b32 s17, s47
    s_mov_b32 s18, 2752
    s_mov_b32 s15, 0x00020000
    s_mov_b32 s19, 0x00020000
    s_cmp_lt_u32 s5, 6
    s_cselect_b32 s92, s36, s38
    s_cselect_b32 s93, s37, s39
    s_mov_b32 s94, 16384
    s_mov_b32 s95, 0x00020000
    s_lshl_b32 s90, s3, 11
    s_lshr_b32 s87, s3, 2
    s_mul_i32 s7, s87, 2112
    v_add_u32 v236, s7, v4
    v_and_b32 v5, 31, v1
    v_lshlrev_b32 v237, 4, v5
    v_cmp_lt_u32 vcc, 15, v5
    v_mov_b32 v16, 256
    v_cmp_ne_u32 s[34:35], 28, v5
    v_cndmask_b32 v237, v237, v16, vcc
    v_cmp_lt_u32 vcc, 16, v5
    v_mov_b32 v16, 0x40000
    s_and_b64 vcc, vcc, s[34:35]
    v_lshrrev_b32 v6, 5, v1
    v_cndmask_b32 v237, v237, v16, vcc
    v_mul_u32_u24 v16, 272, v6
    s_add_u32 s7, s7, 1024
    v_add3_u32 v237, v237, v16, s7
    s_lshr_b32 s60, s3, 1
    v_bfe_u32 v16, v1, 4, 1
    v_lshlrev_b32 v240, 5, v16
    v_bfe_u32 v16, v1, 2, 2
    v_lshl_add_u32 v240, v16, 6, v240
    v_and_b32 v16, 3, v1
    v_lshl_add_u32 v240, v16, 3, v240
    v_lshl_add_u32 v240, v6, 9, v240
    s_mul_i32 s61, s3, 3072
    s_add_u32 s61, s61, 135168
    s_lshl_b32 s62, s3, 11
    v_add_u32 v239, s61, v240
    v_add_u32 v240, s62, v240
    v_bfe_u32 v16, v1, 2, 2
    v_lshl_add_u32 v16, v6, 2, v16
    v_lshlrev_b32 v241, 10, v16
    v_bfe_u32 v16, v1, 4, 1
    v_lshl_add_u32 v241, v16, 6, v241
    v_and_b32 v16, 3, v1
    v_lshl_add_u32 v241, v16, 4, v241
    s_lshl_b32 s6, s5, 7
    v_add_u32 v241, s6, v241
    v_add_u32 v228, 7168, v241
    s_lshl_b32 s7, s69, 2
    s_add_u32 s7, s7, s60
    s_lshl_b32 s7, s7, 3
    v_lshrrev_b32 v5, 3, v1
    v_add_u32 v5, s7, v5
    v_lshlrev_b32 v5, 10, v5
    v_and_b32 v16, 7, v1
    v_lshl_add_u32 v5, v16, 4, v5
    v_add_u32 v242, s6, v5
    s_mov_b32 s76, s48
    s_mov_b32 s77, s49
    s_mov_b32 s78, 1409024
    s_mov_b32 s79, 0x00020000
    s_mov_b32 s96, s40
    s_mov_b32 s97, s41
    s_mov_b32 s98, 524288
    s_mov_b32 s99, 0x00020000
    s_mul_i32 s6, s69, 88064
    s_add_u32 s6, s6, 6291456
    s_add_u32 s64, s54, s6
    s_addc_u32 s65, s55, 0
    s_mov_b32 s66, 88064
    s_mov_b32 s67, 0x00020000
    s_mul_i32 s74, s60, 360448
    s_mul_i32 s75, s60, 22528
    s_lshl_b32 s63, s60, 17
    s_add_u32 s44, s74, 294912
    s_add_u32 s45, s75, 18432
    s_lshr_b32 s6, s4, 2
    s_mul_i32 s6, s6, 9
    s_lshr_b32 s6, s6, 3
    s_lshl_b32 s7, s6, 15
    s_add_u32 s74, s74, s7
    s_lshl_b32 s7, s6, 11
    s_add_u32 s75, s75, s7
    s_lshl_b32 s80, s3, 10
    s_add_u32 s80, s80, 32768
    s_add_u32 s82, s80, 2097152
    s_lshr_b32 s81, s2, 3
    s_mul_i32 s81, s81, 25
    s_lshr_b32 s81, s81, 5
    s_mul_i32 s81, s81, 4096
    v_add_u32 v243, s61, v4
    s_and_b32 s6, s3, 3
    s_lshl_b32 s6, s6, 2
    s_add_u32 s6, s6, 160000
    v_mov_b32 v244, s6
    s_mul_i32 s6, s4, 176128
    s_lshl_b32 s7, s28, 11
    s_add_u32 s6, s6, s7
    s_add_u32 s52, s6, 6291456
    s_add_u32 s53, s52, 88064
    s_lshl_b32 s100, s4, 7
    s_add_u32 s100, s100, s28
    s_lshl_b32 s100, s100, 2
    s_add_u32 s100, s100, 532480
    s_cmp_ge_u32 s24, 2
    s_cbranch_scc1 L_pre_x
    v_lshrrev_b32 v17, 5, v1
    v_lshlrev_b32 v17, 3, v17
    s_lshl_b32 s6, s28, 6
    v_add_u32 v197, s6, v17
    s_lshl_b32 s31, s30, 2
    s_cmp_eq_u32 s30, 6
    s_mov_b32 s6, 3277
    s_cselect_b32 s6, 2731, s6
    s_cselect_b32 s34, 1, 0
    s_and_b32 s35, s85, 1
    s_sub_u32 s7, s3, 2
    s_lshl_b32 s7, s7, 6
    v_add_u32 v3, s7, v1
    v_mul_u32_u24 v8, s6, v3
    v_lshrrev_b32 v8, 16, v8
    v_mul_u32_u24 v10, s31, v8
    v_sub_u32 v3, v3, v10
    v_lshrrev_b32 v3, 2, v3
    v_bfe_u32 v10, v8, 1, 1
    v_and_b32 v10, s34, v10
    v_xor_b32 v3, v3, v10
    v_bfe_u32 v10, v8, 2, 1
    v_and_b32 v10, s34, v10
    v_xor_b32 v10, s35, v10
    v_xor_b32 v8, v8, v10
    s_lshl_b32 s6, s85, 6
    v_lshl_add_u32 v3, v3, 6, s6
    v_lshrrev_b32 v10, 5, v1
    v_lshlrev_b32 v10, 2, v10
    s_lshl_b32 s7, s3, 3
    v_add_u32 v10, s7, v10
    v_bfe_u32 v11, v1, 4, 1
    s_lshl_b32 s7, s5, 7
    v_lshl_add_u32 v11, v11, 6, s7
    s_cmp_lt_u32 s3, 2
    s_cselect_b64 vcc, -1, 0
    v_cndmask_b32 v3, v3, v11, vcc
    v_bfe_u32 v11, v1, 2, 2
    v_add_u32 v10, v10, v11
    v_cndmask_b32 v8, v8, v10, vcc
    v_mul_lo_u32 v8, v8, s26
    v_and_b32 v10, 3, v1
    v_lshl_add_u32 v3, v10, 4, v3
    v_add_u32 v3, v3, v8
    s_lshl_b32 s27, s3, 10
    s_add_u32 s27, s27, 100352
    s_lshl_b32 s26, s26, 4
    s_lshl_b32 s42, s26, 5
    s_lshr_b32 s43, s4, 2
    s_lshl_b32 s43, s43, 2
    s_mul_i32 s25, s43, s26
    v_lshrrev_b32 v11, 5, v1
    v_bfe_u32 v8, v1, 4, 1
    v_lshlrev_b32 v10, 5, v8
    v_bfe_u32 v8, v1, 2, 2
    v_lshl_add_u32 v10, v8, 6, v10
    v_and_b32 v8, 3, v1
    v_lshl_add_u32 v10, v8, 3, v10
    s_mov_b32 s31, 102400
    v_mov_b32 v16, v10
    s_lshl_b32 s6, s30, 6
    v_bfe_u32 v8, v1, 2, 2
    v_lshl_add_u32 v8, v11, 3, v8
    v_bfe_u32 v10, v8, 2, 1
    v_and_b32 v10, s34, v10
    v_xor_b32 v10, s35, v10
    v_xor_b32 v8, v8, v10
    v_mov_b32 v9, s86
    v_bfe_u32 v10, v8, 1, 1
    v_and_b32 v10, s34, v10
    v_xor_b32 v9, v9, v10
    v_mul_u32_u24 v8, s6, v8
    v_lshl_add_u32 v8, v9, 6, v8
    v_and_b32 v9, 0x3f, v16
    v_add3_u32 v192, v8, v9, s31
    v_bfe_u32 v8, v1, 2, 2
    v_lshl_add_u32 v8, v11, 3, v8
    v_add_u32 v8, 4, v8
    v_bfe_u32 v10, v8, 2, 1
    v_and_b32 v10, s34, v10
    v_xor_b32 v10, s35, v10
    v_xor_b32 v8, v8, v10
    v_mov_b32 v9, s86
    v_bfe_u32 v10, v8, 1, 1
    v_and_b32 v10, s34, v10
    v_xor_b32 v9, v9, v10
    v_mul_u32_u24 v8, s6, v8
    v_lshl_add_u32 v8, v9, 6, v8
    v_and_b32 v9, 0x3f, v16
    v_add3_u32 v193, v8, v9, s31
    v_mov_b32 v10, v16
    s_lshr_b32 s7, s3, 1
    s_lshl_b32 s7, s7, 8
    s_add_u32 s7, s7, 100352
    v_lshl_add_u32 v190, v11, 10, v10
    v_add_u32 v190, s7, v190
    v_add_u32 v191, 512, v190
    v_mul_u32_u24 v194, 528, v11
    v_and_b32 v8, 31, v1
    v_lshl_add_u32 v194, v8, 4, v194
    s_mul_i32 s6, s43, 1056
    s_add_u32 s6, s6, 32768
    s_and_b32 s7, s3, 1
    s_cmp_eq_u32 s24, 0
    s_cselect_b32 s7, s7, 0
    s_mul_i32 s31, s7, 33792
    s_add_u32 s6, s6, s31
    v_add_u32 v194, s6, v194
    v_add_u32 v195, 33792, v194
    s_lshl_b32 s7, s7, 7
    s_add_u32 s7, s7, 159744
    v_lshl_add_u32 v196, v8, 2, s7
    s_lshr_b32 s43, s43, 2
    s_sub_u32 s43, 8, s43
L_pre_x:
L_ln:
    s_mov_b32 s57, 0x3f803f80
    s_mov_b32 s58, 0x00003f80
    s_mov_b32 s59, 0x3f800000
    s_waitcnt vmcnt(0)
    s_cmp_lt_u32 s5, 4
    s_cbranch_scc1 L_nokv_1
    s_mov_b32 m0, s90
    s_nop 0
    buffer_load_dwordx4 v4, s[92:95], s90 offen lds
    buffer_load_dwordx4 v4, s[92:95], s90 offen offset:1024 lds
L_nokv_1:
    s_cmp_ge_u32 s24, 2
    s_cbranch_scc1 L_now0
    s_add_u32 m0, s27, 0
    s_add_u32 s6, s25, s26
    buffer_load_dwordx4 v3, s[12:15], s25 offen lds
    s_cmp_eq_u32 s6, s42
    s_cselect_b32 s25, 0, s6
    s_add_u32 m0, s27, 8192
    s_add_u32 s6, s25, s26
    buffer_load_dwordx4 v3, s[12:15], s25 offen lds
    s_cmp_eq_u32 s6, s42
    s_cselect_b32 s25, 0, s6
    s_add_u32 m0, s27, 16384
    s_add_u32 s6, s25, s26
    buffer_load_dwordx4 v3, s[12:15], s25 offen lds
    s_cmp_eq_u32 s6, s42
    s_cselect_b32 s25, 0, s6
L_now0:
    v_dot2_f32_bf16 v18, v24, s57, 0
    v_dot2_f32_bf16 v19, v25, s57, 0
    v_dot2_f32_bf16 v20, v26, s57, 0
    v_dot2_f32_bf16 v21, v27, s57, 0
    v_dot2_f32_bf16 v18, v28, s57, v18
    v_dot2_f32_bf16 v19, v29, s57, v19
    v_dot2_f32_bf16 v20, v30, s57, v20
    v_dot2_f32_bf16 v21, v31, s57, v21
    v_dot2_f32_bf16 v18, v32, s57, v18
    v_dot2_f32_bf16 v19, v33, s57, v19
    v_dot2_f32_bf16 v20, v34, s57, v20
    v_dot2_f32_bf16 v21, v35, s57, v21
    v_dot2_f32_bf16 v18, v36, s57, v18
    v_dot2_f32_bf16 v19, v37, s57, v19
    v_dot2_f32_bf16 v20, v38, s57, v20
    v_dot2_f32_bf16 v21, v39, s57, v21
    v_dot2_f32_bf16 v18, v40, s57, v18
    v_dot2_f32_bf16 v19, v41, s57, v19
    v_dot2_f32_bf16 v20, v42, s57, v20
    v_dot2_f32_bf16 v21, v43, s57, v21
    v_dot2_f32_bf16 v18, v44, s57, v18
    v_dot2_f32_bf16 v19, v45, s57, v19
    v_dot2_f32_bf16 v20, v46, s57, v20
    v_dot2_f32_bf16 v21, v47, s57, v21
    v_dot2_f32_bf16 v18, v48, s57, v18
    v_dot2_f32_bf16 v19, v49, s57, v19
    v_dot2_f32_bf16 v20, v50, s57, v20
    v_dot2_f32_bf16 v21, v51, s57, v21
    v_dot2_f32_bf16 v18, v52, s57, v18
    v_dot2_f32_bf16 v19, v53, s57, v19
    v_dot2_f32_bf16 v20, v54, s57, v20
    v_dot2_f32_bf16 v21, v55, s57, v21
    s_nop 2
    v_add_f32 v18, v18, v19
    v_add_f32 v20, v20, v21
    v_add_f32 v18, v18, v20
    s_nop 1
    v_add_f32_dpp v18, v18, v18 quad_perm:[1,0,3,2] row_mask:0xf bank_mask:0xf
    s_nop 1
    v_add_f32_dpp v18, v18, v18 quad_perm:[2,3,0,1] row_mask:0xf bank_mask:0xf
    s_nop 1
    v_add_f32_dpp v18, v18, v18 row_half_mirror row_mask:0xf bank_mask:0xf
    v_mul_f32 v22, 0x3b000000, v18
    v_dot2_f32_bf16 v10, v24, s58, v22 neg_lo:[0,0,1]
    v_dot2_f32_bf16 v11, v24, s59, v22 neg_lo:[0,0,1]
    v_dot2_f32_bf16 v12, v25, s58, v22 neg_lo:[0,0,1]
    v_dot2_f32_bf16 v13, v25, s59, v22 neg_lo:[0,0,1]
    v_dot2_f32_bf16 v14, v26, s58, v22 neg_lo:[0,0,1]
    v_dot2_f32_bf16 v15, v26, s59, v22 neg_lo:[0,0,1]
    v_cvt_pk_bf16_f32 v24, v10, v11
    v_dot2_f32_bf16 v16, v27, s58, v22 neg_lo:[0,0,1]
    v_dot2_f32_bf16 v17, v27, s59, v22 neg_lo:[0,0,1]
    v_cvt_pk_bf16_f32 v25, v12, v13
    v_dot2_f32_bf16 v10, v28, s58, v22 neg_lo:[0,0,1]
    v_dot2_f32_bf16 v11, v28, s59, v22 neg_lo:[0,0,1]
    v_cvt_pk_bf16_f32 v26, v14, v15
    v_dot2_f32_bf16 v12, v29, s58, v22 neg_lo:[0,0,1]
    v_dot2_f32_bf16 v13, v29, s59, v22 neg_lo:[0,0,1]
    v_cvt_pk_bf16_f32 v27, v16, v17
    ds_write_b128 v7, v[24:27] offset:0
    v_dot2_f32_bf16 v14, v30, s58, v22 neg_lo:[0,0,1]
    v_dot2_f32_bf16 v15, v30, s59, v22 neg_lo:[0,0,1]
    v_cvt_pk_bf16_f32 v28, v10, v11
    v_dot2_f32_bf16 v16, v31, s58, v22 neg_lo:[0,0,1]
    v_dot2_f32_bf16 v17, v31, s59, v22 neg_lo:[0,0,1]
    v_cvt_pk_bf16_f32 v29, v12, v13
    v_dot2_f32_bf16 v10, v32, s58, v22 neg_lo:[0,0,1]
    v_dot2_f32_bf16 v11, v32, s59, v22 neg_lo:[0,0,1]
    v_cvt_pk_bf16_f32 v30, v14, v15
    v_dot2_f32_bf16 v12, v33, s58, v22 neg_lo:[0,0,1]
    v_dot2_f32_bf16 v13, v33, s59, v22 neg_lo:[0,0,1]
    v_cvt_pk_bf16_f32 v31, v16, v17
    ds_write_b128 v7, v[28:31] offset:4224
    v_dot2_f32_bf16 v14, v34, s58, v22 neg_lo:[0,0,1]
    v_dot2_f32_bf16 v15, v34, s59, v22 neg_lo:[0,0,1]
    v_cvt_pk_bf16_f32 v32, v10, v11
    v_dot2_f32_bf16 v16, v35, s58, v22 neg_lo:[0,0,1]
    v_dot2_f32_bf16 v17, v35, s59, v22 neg_lo:[0,0,1]
    v_cvt_pk_bf16_f32 v33, v12, v13
    v_dot2_f32_bf16 v10, v36, s58, v22 neg_lo:[0,0,1]
    v_dot2_f32_bf16 v11, v36, s59, v22 neg_lo:[0,0,1]
    v_cvt_pk_bf16_f32 v34, v14, v15
    v_dot2_f32_bf16 v12, v37, s58, v22 neg_lo:[0,0,1]
    v_dot2_f32_bf16 v13, v37, s59, v22 neg_lo:[0,0,1]
    v_cvt_pk_bf16_f32 v35, v16, v17
    ds_write_b128 v7, v[32:35] offset:8448
    v_dot2_f32_bf16 v14, v38, s58, v22 neg_lo:[0,0,1]
    v_dot2_f32_bf16 v15, v38, s59, v22 neg_lo:[0,0,1]
    v_cvt_pk_bf16_f32 v36, v10, v11
    v_dot2_f32_bf16 v16, v39, s58, v22 neg_lo:[0,0,1]
    v_dot2_f32_bf16 v17, v39, s59, v22 neg_lo:[0,0,1]
    v_cvt_pk_bf16_f32 v37, v12, v13
    v_dot2_f32_bf16 v10, v40, s58, v22 neg_lo:[0,0,1]
    v_dot2_f32_bf16 v11, v40, s59, v22 neg_lo:[0,0,1]
    v_cvt_pk_bf16_f32 v38, v14, v15
    v_dot2_f32_bf16 v12, v41, s58, v22 neg_lo:[0,0,1]
    v_dot2_f32_bf16 v13, v41, s59, v22 neg_lo:[0,0,1]
    v_cvt_pk_bf16_f32 v39, v16, v17
    ds_write_b128 v7, v[36:39] offset:12672
    v_dot2_f32_bf16 v14, v42, s58, v22 neg_lo:[0,0,1]
    v_dot2_f32_bf16 v15, v42, s59, v22 neg_lo:[0,0,1]
    v_cvt_pk_bf16_f32 v40, v10, v11
    v_dot2_f32_bf16 v16, v43, s58, v22 neg_lo:[0,0,1]
    v_dot2_f32_bf16 v17, v43, s59, v22 neg_lo:[0,0,1]
    v_cvt_pk_bf16_f32 v41, v12, v13
    v_dot2_f32_bf16 v10, v44, s58, v22 neg_lo:[0,0,1]
    v_dot2_f32_bf16 v11, v44, s59, v22 neg_lo:[0,0,1]
    v_cvt_pk_bf16_f32 v42, v14, v15
    v_dot2_f32_bf16 v12, v45, s58, v22 neg_lo:[0,0,1]
    v_dot2_f32_bf16 v13, v45, s59, v22 neg_lo:[0,0,1]
    v_cvt_pk_bf16_f32 v43, v16, v17
    ds_write_b128 v7, v[40:43] offset:16896
    v_dot2_f32_bf16 v14, v46, s58, v22 neg_lo:[0,0,1]
    v_dot2_f32_bf16 v15, v46, s59, v22 neg_lo:[0,0,1]
    v_cvt_pk_bf16_f32 v44, v10, v11
    v_dot2_f32_bf16 v16, v47, s58, v22 neg_lo:[0,0,1]
    v_dot2_f32_bf16 v17, v47, s59, v22 neg_lo:[0,0,1]
    v_cvt_pk_bf16_f32 v45, v12, v13
    v_dot2_f32_bf16 v10, v48, s58, v22 neg_lo:[0,0,1]
    v_dot2_f32_bf16 v11, v48, s59, v22 neg_lo:[0,0,1]
    v_cvt_pk_bf16_f32 v46, v14, v15
    v_dot2_f32_bf16 v12, v49, s58, v22 neg_lo:[0,0,1]
    v_dot2_f32_bf16 v13, v49, s59, v22 neg_lo:[0,0,1]
    v_cvt_pk_bf16_f32 v47, v16, v17
    ds_write_b128 v7, v[44:47] offset:21120
    v_dot2_f32_bf16 v14, v50, s58, v22 neg_lo:[0,0,1]
    v_dot2_f32_bf16 v15, v50, s59, v22 neg_lo:[0,0,1]
    v_cvt_pk_bf16_f32 v48, v10, v11
    v_dot2_f32_bf16 v16, v51, s58, v22 neg_lo:[0,0,1]
    v_dot2_f32_bf16 v17, v51, s59, v22 neg_lo:[0,0,1]
    v_cvt_pk_bf16_f32 v49, v12, v13
    v_dot2_f32_bf16 v10, v52, s58, v22 neg_lo:[0,0,1]
    v_dot2_f32_bf16 v11, v52, s59, v22 neg_lo:[0,0,1]
    v_cvt_pk_bf16_f32 v50, v14, v15
    v_dot2_f32_bf16 v12, v53, s58, v22 neg_lo:[0,0,1]
    v_dot2_f32_bf16 v13, v53, s59, v22 neg_lo:[0,0,1]
    v_cvt_pk_bf16_f32 v51, v16, v17
    ds_write_b128 v7, v[48:51] offset:25344
    v_dot2_f32_bf16 v14, v54, s58, v22 neg_lo:[0,0,1]
    v_dot2_f32_bf16 v15, v54, s59, v22 neg_lo:[0,0,1]
    v_cvt_pk_bf16_f32 v52, v10, v11
    v_dot2_f32_bf16 v16, v55, s58, v22 neg_lo:[0,0,1]
    v_dot2_f32_bf16 v17, v55, s59, v22 neg_lo:[0,0,1]
    v_cvt_pk_bf16_f32 v53, v12, v13
    s_nop 1
    v_cvt_pk_bf16_f32 v54, v14, v15
    s_nop 1
    v_cvt_pk_bf16_f32 v55, v16, v17
    ds_write_b128 v7, v[52:55] offset:29568
    v_dot2_f32_bf16 v18, v24, v24, 0
    v_dot2_f32_bf16 v19, v25, v25, 0
    v_dot2_f32_bf16 v20, v26, v26, 0
    v_dot2_f32_bf16 v21, v27, v27, 0
    v_dot2_f32_bf16 v18, v28, v28, v18
    v_dot2_f32_bf16 v19, v29, v29, v19
    v_dot2_f32_bf16 v20, v30, v30, v20
    v_dot2_f32_bf16 v21, v31, v31, v21
    v_dot2_f32_bf16 v18, v32, v32, v18
    v_dot2_f32_bf16 v19, v33, v33, v19
    v_dot2_f32_bf16 v20, v34, v34, v20
    v_dot2_f32_bf16 v21, v35, v35, v21
    v_dot2_f32_bf16 v18, v36, v36, v18
    v_dot2_f32_bf16 v19, v37, v37, v19
    v_dot2_f32_bf16 v20, v38, v38, v20
    v_dot2_f32_bf16 v21, v39, v39, v21
    v_dot2_f32_bf16 v18, v40, v40, v18
    v_dot2_f32_bf16 v19, v41, v41, v19
    v_dot2_f32_bf16 v20, v42, v42, v20
    v_dot2_f32_bf16 v21, v43, v43, v21
    v_dot2_f32_bf16 v18, v44, v44, v18
    v_dot2_f32_bf16 v19, v45, v45, v19
    v_dot2_f32_bf16 v20, v46, v46, v20
    v_dot2_f32_bf16 v21, v47, v47, v21
    v_dot2_f32_bf16 v18, v48, v48, v18
    v_dot2_f32_bf16 v19, v49, v49, v19
    v_dot2_f32_bf16 v20, v50, v50, v20
    v_dot2_f32_bf16 v21, v51, v51, v21
    v_dot2_f32_bf16 v18, v52, v52, v18
    v_dot2_f32_bf16 v19, v53, v53, v19
    v_dot2_f32_bf16 v20, v54, v54, v20
    v_dot2_f32_bf16 v21, v55, v55, v21
    s_nop 2
    v_add_f32 v18, v18, v19
    v_add_f32 v20, v20, v21
    v_add_f32 v18, v18, v20
    s_nop 1
    v_add_f32_dpp v18, v18, v18 quad_perm:[1,0,3,2] row_mask:0xf bank_mask:0xf
    s_nop 1
    v_add_f32_dpp v18, v18, v18 quad_perm:[2,3,0,1] row_mask:0xf bank_mask:0xf
    s_nop 1
    v_add_f32_dpp v18, v18, v18 row_half_mirror row_mask:0xf bank_mask:0xf
    v_mov_b32 v19, 0x3727c5ac
    v_fmac_f32 v19, 0x3b000000, v18
    v_rsq_f32 v19, v19
    s_nop 0
    ds_write_b32 v23, v19
    s_cmp_ge_u32 s24, 2
    s_cbranch_scc1 L_b1x
    s_add_u32 m0, s27, 24576
    s_add_u32 s6, s25, s26
    buffer_load_dwordx4 v3, s[12:15], s25 offen lds
    s_cmp_eq_u32 s6, s42
    s_cselect_b32 s25, 0, s6
    s_add_u32 m0, s27, 32768
    s_add_u32 s6, s25, s26
    buffer_load_dwordx4 v3, s[12:15], s25 offen lds
    s_cmp_eq_u32 s6, s42
    s_cselect_b32 s25, 0, s6
    s_add_u32 m0, s27, 40960
    s_add_u32 s6, s25, s26
    buffer_load_dwordx4 v3, s[12:15], s25 offen lds
    s_cmp_eq_u32 s6, s42
    s_cselect_b32 s25, 0, s6
    s_add_u32 m0, s27, 49152
    s_add_u32 s6, s25, s26
    buffer_load_dwordx4 v3, s[12:15], s25 offen lds
    s_cmp_eq_u32 s6, s42
    s_cselect_b32 s25, 0, s6
    s_waitcnt vmcnt(5) lgkmcnt(0)
    s_mul_i32 s56, s56, 0x9E3779B1
    s_add_u32 s56, s56, 0x85EBCA6B
    s_mov_b32 s31, 4224
    s_barrier
    buffer_load_dwordx2 v[56:57], v197, s[16:19], 0 offen offset:0
    buffer_load_dwordx2 v[58:59], v197, s[16:19], 0 offen offset:16
    buffer_load_dwordx2 v[60:61], v197, s[16:19], 0 offen offset:32
    buffer_load_dwordx2 v[62:63], v197, s[16:19], 0 offen offset:48
    s_cmp_eq_u32 s24, 0
    s_cbranch_scc1 L_ga
    ds_read_b64_tr_b16 v[96:97], v192 offset:0
    ds_read_b64_tr_b16 v[98:99], v193 offset:0
    ds_read_b128 v[100:103], v194 offset:0
    ds_read_b128 v[104:107], v195 offset:0
    ds_read_b64_tr_b16 v[108:109], v192 offset:8192
    ds_read_b64_tr_b16 v[110:111], v193 offset:8192
    ds_read_b128 v[112:115], v194 offset:1056
    ds_read_b128 v[116:119], v195 offset:1056
    s_waitcnt vmcnt(8) lgkmcnt(4)
    s_barrier
    v_mfma_f32_32x32x16_bf16 v[64:79], v[96:99], v[100:103], 0
    ds_read_b64_tr_b16 v[120:121], v192 offset:16384
    ds_read_b64_tr_b16 v[122:123], v193 offset:16384
    ds_read_b128 v[124:127], v194 offset:2112
    ds_read_b128 v[128:131], v195 offset:2112
    s_add_u32 m0, s27, 0
    s_add_u32 s6, s25, s26
    buffer_load_dwordx4 v3, s[12:15], s25 offen lds
    s_cmp_eq_u32 s6, s42
    s_cselect_b32 s25, 0, s6
    v_mfma_f32_32x32x16_bf16 v[80:95], v[96:99], v[104:107], 0
    s_waitcnt vmcnt(8) lgkmcnt(4)
    s_barrier
    v_mfma_f32_32x32x16_bf16 v[64:79], v[108:111], v[112:115], v[64:79]
    ds_read_b64_tr_b16 v[96:97], v192 offset:24576
    ds_read_b64_tr_b16 v[98:99], v193 offset:24576
    ds_read_b128 v[100:103], v194 offset:3168
    ds_read_b128 v[104:107], v195 offset:3168
    s_add_u32 m0, s27, 8192
    s_add_u32 s6, s25, s26
    buffer_load_dwordx4 v3, s[12:15], s25 offen lds
    s_cmp_eq_u32 s6, s42
    s_cselect_b32 s25, 0, s6
    v_mfma_f32_32x32x16_bf16 v[80:95], v[108:111], v[116:119], v[80:95]
    s_waitcnt vmcnt(8) lgkmcnt(4)
    s_barrier
    v_mfma_f32_32x32x16_bf16 v[64:79], v[120:123], v[124:127], v[64:79]
    s_sub_u32 s43, s43, 1
    s_cmp_eq_u32 s43, 0
    s_cselect_b32 s7, 4294937728, s31
    v_add_u32 v194, s7, v194
    v_add_u32 v195, s7, v195
    ds_read_b64_tr_b16 v[108:109], v192 offset:32768
    ds_read_b64_tr_b16 v[110:111], v193 offset:32768
    ds_read_b128 v[112:115], v194 offset:0
    ds_read_b128 v[116:119], v195 offset:0
    s_add_u32 m0, s27, 16384
    s_add_u32 s6, s25, s26
    buffer_load_dwordx4 v3, s[12:15], s25 offen lds
    s_cmp_eq_u32 s6, s42
    s_cselect_b32 s25, 0, s6
    v_mfma_f32_32x32x16_bf16 v[80:95], v[120:123], v[128:131], v[80:95]
    s_waitcnt vmcnt(8) lgkmcnt(4)
    s_barrier
    v_mfma_f32_32x32x16_bf16 v[64:79], v[96:99], v[100:103], v[64:79]
    ds_read_b64_tr_b16 v[120:121], v192 offset:40960
    ds_read_b64_tr_b16 v[122:123], v193 offset:40960
    ds_read_b128 v[124:127], v194 offset:1056
    ds_read_b128 v[128:131], v195 offset:1056
    s_add_u32 m0, s27, 24576
    s_add_u32 s6, s25, s26
    buffer_load_dwordx4 v3, s[12:15], s25 offen lds
    s_cmp_eq_u32 s6, s42
    s_cselect_b32 s25, 0, s6
    v_mfma_f32_32x32x16_bf16 v[80:95], v[96:99], v[104:107], v[80:95]
    s_waitcnt vmcnt(8) lgkmcnt(4)
    s_barrier
    v_mfma_f32_32x32x16_bf16 v[64:79], v[108:111], v[112:115], v[64:79]
    ds_read_b32 v22, v196
    ds_read_b32 v20, v196 offset:128
    ds_read_b64_tr_b16 v[96:97], v192 offset:49152
    ds_read_b64_tr_b16 v[98:99], v193 offset:49152
    ds_read_b128 v[100:103], v194 offset:2112
    ds_read_b128 v[104:107], v195 offset:2112
    s_add_u32 m0, s27, 32768
    s_add_u32 s6, s25, s26
    buffer_load_dwordx4 v3, s[12:15], s25 offen lds
    s_cmp_eq_u32 s6, s42
    s_cselect_b32 s25, 0, s6
    v_mfma_f32_32x32x16_bf16 v[80:95], v[108:111], v[116:119], v[80:95]
    s_waitcnt vmcnt(4) lgkmcnt(6)
    s_barrier
    v_mfma_f32_32x32x16_bf16 v[64:79], v[120:123], v[124:127], v[64:79]
    ds_read_b64_tr_b16 v[108:109], v192 offset:0
    ds_read_b64_tr_b16 v[110:111], v193 offset:0
    ds_read_b128 v[112:115], v194 offset:3168
    ds_read_b128 v[116:119], v195 offset:3168
    s_add_u32 m0, s27, 40960
    s_add_u32 s6, s25, s26
    buffer_load_dwordx4 v3, s[12:15], s25 offen lds
    s_cmp_eq_u32 s6, s42
    s_cselect_b32 s25, 0, s6
    v_mfma_f32_32x32x16_bf16 v[80:95], v[120:123], v[128:131], v[80:95]
    s_waitcnt vmcnt(4) lgkmcnt(4)
    s_barrier
    v_mfma_f32_32x32x16_bf16 v[64:79], v[96:99], v[100:103], v[64:79]
    s_sub_u32 s43, s43, 1
    s_cmp_eq_u32 s43, 0
    s_cselect_b32 s7, 4294937728, s31
    v_add_u32 v194, s7, v194
    v_add_u32 v195, s7, v195
    ds_read_b64_tr_b16 v[120:121], v192 offset:8192
    ds_read_b64_tr_b16 v[122:123], v193 offset:8192
    ds_read_b128 v[124:127], v194 offset:0
    ds_read_b128 v[128:131], v195 offset:0
    s_add_u32 m0, s27, 49152
    s_add_u32 s6, s25, s26
    buffer_load_dwordx4 v3, s[12:15], s25 offen lds
    s_cmp_eq_u32 s6, s42
    s_cselect_b32 s25, 0, s6
    v_mfma_f32_32x32x16_bf16 v[80:95], v[96:99], v[104:107], v[80:95]
    s_waitcnt vmcnt(4) lgkmcnt(4)
    s_barrier
    v_mfma_f32_32x32x16_bf16 v[64:79], v[108:111], v[112:115], v[64:79]
    ds_read_b64_tr_b16 v[96:97], v192 offset:16384
    ds_read_b64_tr_b16 v[98:99], v193 offset:16384
    ds_read_b128 v[100:103], v194 offset:1056
    ds_read_b128 v[104:107], v195 offset:1056
    s_add_u32 m0, s27, 0
    s_add_u32 s6, s25, s26
    buffer_load_dwordx4 v3, s[12:15], s25 offen lds
    s_cmp_eq_u32 s6, s42
    s_cselect_b32 s25, 0, s6
    v_mfma_f32_32x32x16_bf16 v[80:95], v[108:111], v[116:119], v[80:95]
    s_waitcnt vmcnt(4) lgkmcnt(4)
    s_barrier
    v_mfma_f32_32x32x16_bf16 v[64:79], v[120:123], v[124:127], v[64:79]
    ds_read_b64_tr_b16 v[108:109], v192 offset:24576
    ds_read_b64_tr_b16 v[110:111], v193 offset:24576
    ds_read_b128 v[112:115], v194 offset:2112
    ds_read_b128 v[116:119], v195 offset:2112
    s_add_u32 m0, s27, 8192
    s_add_u32 s6, s25, s26
    buffer_load_dwordx4 v3, s[12:15], s25 offen lds
    s_cmp_eq_u32 s6, s42
    s_cselect_b32 s25, 0, s6
    v_mfma_f32_32x32x16_bf16 v[80:95], v[120:123], v[128:131], v[80:95]
    v_lshlrev_b32 v164, 16, v56
    v_and_b32 v165, 0xffff0000, v56
    v_lshlrev_b32 v166, 16, v57
    v_and_b32 v167, 0xffff0000, v57
    v_lshlrev_b32 v168, 16, v58
    v_and_b32 v169, 0xffff0000, v58
    v_lshlrev_b32 v170, 16, v59
    v_and_b32 v171, 0xffff0000, v59
    v_lshlrev_b32 v172, 16, v60
    v_and_b32 v173, 0xffff0000, v60
    v_lshlrev_b32 v174, 16, v61
    v_and_b32 v175, 0xffff0000, v61
    v_lshlrev_b32 v176, 16, v62
    v_and_b32 v177, 0xffff0000, v62
    v_lshlrev_b32 v178, 16, v63
    v_and_b32 v179, 0xffff0000, v63
    s_mov_b32 s6, 0x3fb8aa3b
    v_pk_mul_f32 v[164:165], v[164:165], s[6:7] op_sel_hi:[1,0]
    v_pk_mul_f32 v[166:167], v[166:167], s[6:7] op_sel_hi:[1,0]
    v_pk_mul_f32 v[168:169], v[168:169], s[6:7] op_sel_hi:[1,0]
    v_pk_mul_f32 v[170:171], v[170:171], s[6:7] op_sel_hi:[1,0]
    v_pk_mul_f32 v[172:173], v[172:173], s[6:7] op_sel_hi:[1,0]
    v_pk_mul_f32 v[174:175], v[174:175], s[6:7] op_sel_hi:[1,0]
    v_pk_mul_f32 v[176:177], v[176:177], s[6:7] op_sel_hi:[1,0]
    v_pk_mul_f32 v[178:179], v[178:179], s[6:7] op_sel_hi:[1,0]
    s_waitcnt vmcnt(4) lgkmcnt(4)
    s_barrier
    v_mfma_f32_32x32x16_bf16 v[64:79], v[96:99], v[100:103], v[64:79]
    ds_read_b64_tr_b16 v[120:121], v192 offset:32768
    ds_read_b64_tr_b16 v[122:123], v193 offset:32768
    ds_read_b128 v[124:127], v194 offset:3168
    ds_read_b128 v[128:131], v195 offset:3168
    s_add_u32 m0, s27, 16384
    s_add_u32 s6, s25, s26
    buffer_load_dwordx4 v3, s[12:15], s25 offen lds
    s_cmp_eq_u32 s6, s42
    s_cselect_b32 s25, 0, s6
    v_mfma_f32_32x32x16_bf16 v[80:95], v[96:99], v[104:107], v[80:95]
    s_waitcnt vmcnt(4) lgkmcnt(4)
    s_barrier
    v_mfma_f32_32x32x16_bf16 v[64:79], v[108:111], v[112:115], v[64:79]
    s_sub_u32 s43, s43, 1
    s_cmp_eq_u32 s43, 0
    s_cselect_b32 s7, 4294937728, s31
    v_add_u32 v194, s7, v194
    v_add_u32 v195, s7, v195
    ds_read_b64_tr_b16 v[96:97], v192 offset:40960
    ds_read_b64_tr_b16 v[98:99], v193 offset:40960
    ds_read_b128 v[100:103], v194 offset:0
    ds_read_b128 v[104:107], v195 offset:0
    s_add_u32 m0, s27, 24576
    s_add_u32 s6, s25, s26
    buffer_load_dwordx4 v3, s[12:15], s25 offen lds
    s_cmp_eq_u32 s6, s42
    s_cselect_b32 s25, 0, s6
    v_mfma_f32_32x32x16_bf16 v[80:95], v[108:111], v[116:119], v[80:95]
    s_waitcnt vmcnt(4) lgkmcnt(4)
    s_barrier
    v_mfma_f32_32x32x16_bf16 v[64:79], v[120:123], v[124:127], v[64:79]
    ds_read_b64_tr_b16 v[108:109], v192 offset:49152
    ds_read_b64_tr_b16 v[110:111], v193 offset:49152
    ds_read_b128 v[112:115], v194 offset:1056
    ds_read_b128 v[116:119], v195 offset:1056
    s_add_u32 m0, s27, 32768
    s_add_u32 s6, s25, s26
    buffer_load_dwordx4 v3, s[12:15], s25 offen lds
    s_cmp_eq_u32 s6, s42
    s_cselect_b32 s25, 0, s6
    v_mfma_f32_32x32x16_bf16 v[80:95], v[120:123], v[128:131], v[80:95]
    s_waitcnt vmcnt(4) lgkmcnt(4)
    s_barrier
    v_mfma_f32_32x32x16_bf16 v[64:79], v[96:99], v[100:103], v[64:79]
    ds_read_b64_tr_b16 v[120:121], v192 offset:0
    ds_read_b64_tr_b16 v[122:123], v193 offset:0
    ds_read_b128 v[124:127], v194 offset:2112
    ds_read_b128 v[128:131], v195 offset:2112
    s_add_u32 m0, s27, 40960
    s_add_u32 s6, s25, s26
    buffer_load_dwordx4 v3, s[12:15], s25 offen lds
    s_cmp_eq_u32 s6, s42
    s_cselect_b32 s25, 0, s6
    v_mfma_f32_32x32x16_bf16 v[80:95], v[96:99], v[104:107], v[80:95]
    s_waitcnt vmcnt(4) lgkmcnt(4)
    s_barrier
    v_mfma_f32_32x32x16_bf16 v[64:79], v[108:111], v[112:115], v[64:79]
    ds_read_b64_tr_b16 v[96:97], v192 offset:8192
    ds_read_b64_tr_b16 v[98:99], v193 offset:8192
    ds_read_b128 v[100:103], v194 offset:3168
    ds_read_b128 v[104:107], v195 offset:3168
    s_add_u32 m0, s27, 49152
    s_add_u32 s6, s25, s26
    buffer_load_dwordx4 v3, s[12:15], s25 offen lds
    s_cmp_eq_u32 s6, s42
    s_cselect_b32 s25, 0, s6
    v_mfma_f32_32x32x16_bf16 v[80:95], v[108:111], v[116:119], v[80:95]
    s_waitcnt vmcnt(4) lgkmcnt(4)
    s_barrier
    v_mfma_f32_32x32x16_bf16 v[64:79], v[120:123], v[124:127], v[64:79]
    s_sub_u32 s43, s43, 1
    s_cmp_eq_u32 s43, 0
    s_cselect_b32 s7, 4294937728, s31
    v_add_u32 v194, s7, v194
    v_add_u32 v195, s7, v195
    ds_read_b64_tr_b16 v[108:109], v192 offset:16384
    ds_read_b64_tr_b16 v[110:111], v193 offset:16384
    ds_read_b128 v[112:115], v194 offset:0
    ds_read_b128 v[116:119], v195 offset:0
    s_add_u32 m0, s27, 0
    s_add_u32 s6, s25, s26
    buffer_load_dwordx4 v3, s[12:15], s25 offen lds
    s_cmp_eq_u32 s6, s42
    s_cselect_b32 s25, 0, s6
    v_mfma_f32_32x32x16_bf16 v[80:95], v[120:123], v[128:131], v[80:95]
    s_waitcnt vmcnt(4) lgkmcnt(4)
    s_barrier
    v_mfma_f32_32x32x16_bf16 v[64:79], v[96:99], v[100:103], v[64:79]
    ds_read_b64_tr_b16 v[120:121], v192 offset:24576
    ds_read_b64_tr_b16 v[122:123], v193 offset:24576
    ds_read_b128 v[124:127], v194 offset:1056
    ds_read_b128 v[128:131], v195 offset:1056
    s_add_u32 m0, s27, 8192
    s_add_u32 s6, s25, s26
    buffer_load_dwordx4 v3, s[12:15], s25 offen lds
    s_cmp_eq_u32 s6, s42
    s_cselect_b32 s25, 0, s6
    v_mfma_f32_32x32x16_bf16 v[80:95], v[96:99], v[104:107], v[80:95]
    s_waitcnt vmcnt(4) lgkmcnt(4)
    s_barrier
    v_mfma_f32_32x32x16_bf16 v[64:79], v[108:111], v[112:115], v[64:79]
    ds_read_b64_tr_b16 v[96:97], v192 offset:32768
    ds_read_b64_tr_b16 v[98:99], v193 offset:32768
    ds_read_b128 v[100:103], v194 offset:2112
    ds_read_b128 v[104:107], v195 offset:2112
    s_add_u32 m0, s27, 16384
    s_add_u32 s6, s25, s26
    buffer_load_dwordx4 v3, s[12:15], s25 offen lds
    s_cmp_eq_u32 s6, s42
    s_cselect_b32 s25, 0, s6
    v_mfma_f32_32x32x16_bf16 v[80:95], v[108:111], v[116:119], v[80:95]
    s_waitcnt vmcnt(4) lgkmcnt(4)
    s_barrier
    v_mfma_f32_32x32x16_bf16 v[64:79], v[120:123], v[124:127], v[64:79]
    ds_read_b64_tr_b16 v[108:109], v192 offset:40960
    ds_read_b64_tr_b16 v[110:111], v193 offset:40960
    ds_read_b128 v[112:115], v194 offset:3168
    ds_read_b128 v[116:119], v195 offset:3168
    s_add_u32 m0, s27, 24576
    s_add_u32 s6, s25, s26
    buffer_load_dwordx4 v3, s[12:15], s25 offen lds
    s_cmp_eq_u32 s6, s42
    s_cselect_b32 s25, 0, s6
    v_mfma_f32_32x32x16_bf16 v[80:95], v[120:123], v[128:131], v[80:95]
    s_waitcnt vmcnt(4) lgkmcnt(4)
    s_barrier
    v_mfma_f32_32x32x16_bf16 v[64:79], v[96:99], v[100:103], v[64:79]
    s_sub_u32 s43, s43, 1
    s_cmp_eq_u32 s43, 0
    s_cselect_b32 s7, 4294937728, s31
    v_add_u32 v194, s7, v194
    v_add_u32 v195, s7, v195
    ds_read_b64_tr_b16 v[120:121], v192 offset:49152
    ds_read_b64_tr_b16 v[122:123], v193 offset:49152
    ds_read_b128 v[124:127], v194 offset:0
    ds_read_b128 v[128:131], v195 offset:0
    s_add_u32 m0, s27, 32768
    s_add_u32 s6, s25, s26
    buffer_load_dwordx4 v3, s[12:15], s25 offen lds
    s_cmp_eq_u32 s6, s42
    s_cselect_b32 s25, 0, s6
    v_mfma_f32_32x32x16_bf16 v[80:95], v[96:99], v[104:107], v[80:95]
    s_waitcnt vmcnt(4) lgkmcnt(4)
    s_barrier
    v_mfma_f32_32x32x16_bf16 v[64:79], v[108:111], v[112:115], v[64:79]
    ds_read_b64_tr_b16 v[96:97], v192 offset:0
    ds_read_b64_tr_b16 v[98:99], v193 offset:0
    ds_read_b128 v[100:103], v194 offset:1056
    ds_read_b128 v[104:107], v195 offset:1056
    s_add_u32 m0, s27, 40960
    s_add_u32 s6, s25, s26
    buffer_load_dwordx4 v3, s[12:15], s25 offen lds
    s_cmp_eq_u32 s6, s42
    s_cselect_b32 s25, 0, s6
    v_mfma_f32_32x32x16_bf16 v[80:95], v[108:111], v[116:119], v[80:95]
    s_waitcnt vmcnt(4) lgkmcnt(4)
    s_barrier
    v_mfma_f32_32x32x16_bf16 v[64:79], v[120:123], v[124:127], v[64:79]
    ds_read_b64_tr_b16 v[108:109], v192 offset:8192
    ds_read_b64_tr_b16 v[110:111], v193 offset:8192
    ds_read_b128 v[112:115], v194 offset:2112
    ds_read_b128 v[116:119], v195 offset:2112
    s_add_u32 m0, s27, 49152
    s_add_u32 s6, s25, s26
    buffer_load_dwordx4 v3, s[12:15], s25 offen lds
    s_cmp_eq_u32 s6, s42
    s_cselect_b32 s25, 0, s6
    v_mfma_f32_32x32x16_bf16 v[80:95], v[120:123], v[128:131], v[80:95]
    s_waitcnt vmcnt(4) lgkmcnt(4)
    s_barrier
    v_mfma_f32_32x32x16_bf16 v[64:79], v[96:99], v[100:103], v[64:79]
    ds_read_b64_tr_b16 v[120:121], v192 offset:16384
    ds_read_b64_tr_b16 v[122:123], v193 offset:16384
    ds_read_b128 v[124:127], v194 offset:3168
    ds_read_b128 v[128:131], v195 offset:3168
    s_add_u32 m0, s27, 0
    s_add_u32 s6, s25, s26
    buffer_load_dwordx4 v3, s[12:15], s25 offen lds
    s_cmp_eq_u32 s6, s42
    s_cselect_b32 s25, 0, s6
    v_mfma_f32_32x32x16_bf16 v[80:95], v[96:99], v[104:107], v[80:95]
    s_waitcnt vmcnt(4) lgkmcnt(4)
    s_barrier
    v_mfma_f32_32x32x16_bf16 v[64:79], v[108:111], v[112:115], v[64:79]
    s_sub_u32 s43, s43, 1
    s_cmp_eq_u32 s43, 0
    s_cselect_b32 s7, 4294937728, s31
    v_add_u32 v194, s7, v194
    v_add_u32 v195, s7, v195
    ds_read_b64_tr_b16 v[96:97], v192 offset:24576
    ds_read_b64_tr_b16 v[98:99], v193 offset:24576
    ds_read_b128 v[100:103], v194 offset:0
    ds_read_b128 v[104:107], v195 offset:0
    s_add_u32 m0, s27, 8192
    s_add_u32 s6, s25, s26
    buffer_load_dwordx4 v3, s[12:15], s25 offen lds
    s_cmp_eq_u32 s6, s42
    s_cselect_b32 s25, 0, s6
    v_mfma_f32_32x32x16_bf16 v[80:95], v[108:111], v[116:119], v[80:95]
    s_waitcnt vmcnt(4) lgkmcnt(4)
    s_barrier
    v_mfma_f32_32x32x16_bf16 v[64:79], v[120:123], v[124:127], v[64:79]
    ds_read_b64_tr_b16 v[108:109], v192 offset:32768
    ds_read_b64_tr_b16 v[110:111], v193 offset:32768
    ds_read_b128 v[112:115], v194 offset:1056
    ds_read_b128 v[116:119], v195 offset:1056
    s_add_u32 m0, s27, 16384
    s_add_u32 s6, s25, s26
    buffer_load_dwordx4 v3, s[12:15], s25 offen lds
    s_cmp_eq_u32 s6, s42
    s_cselect_b32 s25, 0, s6
    v_mfma_f32_32x32x16_bf16 v[80:95], v[120:123], v[128:131], v[80:95]
    s_waitcnt vmcnt(4) lgkmcnt(4)
    s_barrier
    v_mfma_f32_32x32x16_bf16 v[64:79], v[96:99], v[100:103], v[64:79]
    ds_read_b64_tr_b16 v[120:121], v192 offset:40960
    ds_read_b64_tr_b16 v[122:123], v193 offset:40960
    ds_read_b128 v[124:127], v194 offset:2112
    ds_read_b128 v[128:131], v195 offset:2112
    s_add_u32 m0, s27, 24576
    s_add_u32 s6, s25, s26
    buffer_load_dwordx4 v3, s[12:15], s25 offen lds
    s_cmp_eq_u32 s6, s42
    s_cselect_b32 s25, 0, s6
    v_mfma_f32_32x32x16_bf16 v[80:95], v[96:99], v[104:107], v[80:95]
    s_waitcnt vmcnt(4) lgkmcnt(4)
    s_barrier
    v_mfma_f32_32x32x16_bf16 v[64:79], v[108:111], v[112:115], v[64:79]
    ds_read_b64_tr_b16 v[96:97], v192 offset:49152
    ds_read_b64_tr_b16 v[98:99], v193 offset:49152
    ds_read_b128 v[100:103], v194 offset:3168
    ds_read_b128 v[104:107], v195 offset:3168
    v_mfma_f32_32x32x16_bf16 v[80:95], v[108:111], v[116:119], v[80:95]
    s_waitcnt vmcnt(3) lgkmcnt(4)
    s_barrier
    v_mfma_f32_32x32x16_bf16 v[64:79], v[120:123], v[124:127], v[64:79]
    s_sub_u32 s43, s43, 1
    s_cmp_eq_u32 s43, 0
    s_cselect_b32 s7, 4294937728, s31
    v_add_u32 v194, s7, v194
    v_add_u32 v195, s7, v195
    ds_read_b64_tr_b16 v[108:109], v192 offset:0
    ds_read_b64_tr_b16 v[110:111], v193 offset:0
    ds_read_b128 v[112:115], v194 offset:0
    ds_read_b128 v[116:119], v195 offset:0
    v_mfma_f32_32x32x16_bf16 v[80:95], v[120:123], v[128:131], v[80:95]
    s_waitcnt vmcnt(2) lgkmcnt(4)
    s_barrier
    v_mfma_f32_32x32x16_bf16 v[64:79], v[96:99], v[100:103], v[64:79]
    ds_read_b64_tr_b16 v[120:121], v192 offset:8192
    ds_read_b64_tr_b16 v[122:123], v193 offset:8192
    ds_read_b128 v[124:127], v194 offset:1056
    ds_read_b128 v[128:131], v195 offset:1056
    v_mfma_f32_32x32x16_bf16 v[80:95], v[96:99], v[104:107], v[80:95]
    s_waitcnt vmcnt(1) lgkmcnt(4)
    s_barrier
    v_mfma_f32_32x32x16_bf16 v[64:79], v[108:111], v[112:115], v[64:79]
    ds_read_b64_tr_b16 v[96:97], v192 offset:16384
    ds_read_b64_tr_b16 v[98:99], v193 offset:16384
    ds_read_b128 v[100:103], v194 offset:2112
    ds_read_b128 v[104:107], v195 offset:2112
    v_mfma_f32_32x32x16_bf16 v[80:95], v[108:111], v[116:119], v[80:95]
    s_waitcnt vmcnt(0) lgkmcnt(4)
    s_barrier
    v_mfma_f32_32x32x16_bf16 v[64:79], v[120:123], v[124:127], v[64:79]
    ds_read_b64_tr_b16 v[108:109], v192 offset:24576
    ds_read_b64_tr_b16 v[110:111], v193 offset:24576
    ds_read_b128 v[112:115], v194 offset:3168
    ds_read_b128 v[116:119], v195 offset:3168
    v_mfma_f32_32x32x16_bf16 v[80:95], v[120:123], v[128:131], v[80:95]
    v_mov_b32 v40, -1
    v_mov_b32 v41, -1
    v_mov_b32 v42, -1
    v_mov_b32 v43, -1
    buffer_store_dwordx4 v[40:43], v4, s[20:23], s68 offen sc1
    s_waitcnt lgkmcnt(4)
    v_mfma_f32_32x32x16_bf16 v[64:79], v[96:99], v[100:103], v[64:79]
    v_mfma_f32_32x32x16_bf16 v[80:95], v[96:99], v[104:107], v[80:95]
    s_waitcnt lgkmcnt(0)
    v_mfma_f32_32x32x16_bf16 v[64:79], v[108:111], v[112:115], v[64:79]
    v_mfma_f32_32x32x16_bf16 v[80:95], v[108:111], v[116:119], v[80:95]
    s_branch L_b2
L_ga:
    ds_read_b64_tr_b16 v[96:97], v190 offset:0
    ds_read_b64_tr_b16 v[98:99], v191 offset:0
    ds_read_b128 v[100:103], v194 offset:0
    ds_read_b64_tr_b16 v[104:105], v192 offset:0
    ds_read_b64_tr_b16 v[106:107], v193 offset:0
    ds_read_b64_tr_b16 v[108:109], v190 offset:8192
    ds_read_b64_tr_b16 v[110:111], v191 offset:8192
    ds_read_b128 v[112:115], v194 offset:1056
    ds_read_b64_tr_b16 v[116:117], v192 offset:8192
    ds_read_b64_tr_b16 v[118:119], v193 offset:8192
    s_mov_b32 s83, 528384
    s_waitcnt vmcnt(8) lgkmcnt(5)
    s_barrier
    v_mfma_f32_32x32x16_bf16 v[64:79], v[96:99], v[100:103], 0
    ds_read_b64_tr_b16 v[120:121], v190 offset:16384
    ds_read_b64_tr_b16 v[122:123], v191 offset:16384
    ds_read_b128 v[124:127], v194 offset:2112
    ds_read_b64_tr_b16 v[128:129], v192 offset:16384
    ds_read_b64_tr_b16 v[130:131], v193 offset:16384
    s_add_u32 m0, s27, 0
    s_add_u32 s6, s25, s26
    buffer_load_dwordx4 v3, s[12:15], s25 offen lds
    s_cmp_eq_u32 s6, s42
    s_cselect_b32 s25, 0, s6
    v_mfma_f32_32x32x16_bf16 v[80:95], v[104:107], v[100:103], 0
    s_waitcnt vmcnt(8) lgkmcnt(5)
    s_barrier
    v_mfma_f32_32x32x16_bf16 v[64:79], v[108:111], v[112:115], v[64:79]
    ds_read_b64_tr_b16 v[96:97], v190 offset:24576
    ds_read_b64_tr_b16 v[98:99], v191 offset:24576
    ds_read_b128 v[100:103], v194 offset:3168
    ds_read_b64_tr_b16 v[104:105], v192 offset:24576
    ds_read_b64_tr_b16 v[106:107], v193 offset:24576
    s_add_u32 m0, s27, 8192
    s_add_u32 s6, s25, s26
    buffer_load_dwordx4 v3, s[12:15], s25 offen lds
    s_cmp_eq_u32 s6, s42
    s_cselect_b32 s25, 0, s6
    v_mfma_f32_32x32x16_bf16 v[80:95], v[116:119], v[112:115], v[80:95]
    s_waitcnt vmcnt(8) lgkmcnt(5)
    s_barrier
    v_mfma_f32_32x32x16_bf16 v[64:79], v[120:123], v[124:127], v[64:79]
    s_sub_u32 s43, s43, 1
    s_cmp_eq_u32 s43, 0
    s_cselect_b32 s7, 4294937728, s31
    v_add_u32 v194, s7, v194
    ds_read_b64_tr_b16 v[108:109], v190 offset:32768
    ds_read_b64_tr_b16 v[110:111], v191 offset:32768
    ds_read_b128 v[112:115], v194 offset:0
    ds_read_b64_tr_b16 v[116:117], v192 offset:32768
    ds_read_b64_tr_b16 v[118:119], v193 offset:32768
    s_add_u32 m0, s27, 16384
    s_add_u32 s6, s25, s26
    buffer_load_dwordx4 v3, s[12:15], s25 offen lds
    s_cmp_eq_u32 s6, s42
    s_cselect_b32 s25, 0, s6
    v_mfma_f32_32x32x16_bf16 v[80:95], v[128:131], v[124:127], v[80:95]
    s_waitcnt vmcnt(8) lgkmcnt(5)
    s_barrier
    v_mfma_f32_32x32x16_bf16 v[64:79], v[96:99], v[100:103], v[64:79]
    ds_read_b64_tr_b16 v[120:121], v190 offset:40960
    ds_read_b64_tr_b16 v[122:123], v191 offset:40960
    ds_read_b128 v[124:127], v194 offset:1056
    ds_read_b64_tr_b16 v[128:129], v192 offset:40960
    ds_read_b64_tr_b16 v[130:131], v193 offset:40960
    s_add_u32 m0, s27, 24576
    s_add_u32 s6, s25, s26
    buffer_load_dwordx4 v3, s[12:15], s25 offen lds
    s_cmp_eq_u32 s6, s42
    s_cselect_b32 s25, 0, s6
    v_mfma_f32_32x32x16_bf16 v[80:95], v[104:107], v[100:103], v[80:95]
    s_waitcnt vmcnt(8) lgkmcnt(5)
    s_barrier
    v_mfma_f32_32x32x16_bf16 v[64:79], v[108:111], v[112:115], v[64:79]
    ds_read_b32 v22, v196
    ds_read_b64_tr_b16 v[96:97], v190 offset:49152
    ds_read_b64_tr_b16 v[98:99], v191 offset:49152
    ds_read_b128 v[100:103], v194 offset:2112
    ds_read_b64_tr_b16 v[104:105], v192 offset:49152
    ds_read_b64_tr_b16 v[106:107], v193 offset:49152
    s_add_u32 m0, s27, 32768
    s_add_u32 s6, s25, s26
    buffer_load_dwordx4 v3, s[12:15], s25 offen lds
    s_cmp_eq_u32 s6, s42
    s_cselect_b32 s25, 0, s6
    v_mfma_f32_32x32x16_bf16 v[80:95], v[116:119], v[112:115], v[80:95]
    s_waitcnt vmcnt(4) lgkmcnt(6)
    s_barrier
    v_mfma_f32_32x32x16_bf16 v[64:79], v[120:123], v[124:127], v[64:79]
    ds_read_b64_tr_b16 v[108:109], v190 offset:0
    ds_read_b64_tr_b16 v[110:111], v191 offset:0
    ds_read_b128 v[112:115], v194 offset:3168
    ds_read_b64_tr_b16 v[116:117], v192 offset:0
    ds_read_b64_tr_b16 v[118:119], v193 offset:0
    s_add_u32 m0, s27, 40960
    s_add_u32 s6, s25, s26
    buffer_load_dwordx4 v3, s[12:15], s25 offen lds
    s_cmp_eq_u32 s6, s42
    s_cselect_b32 s25, 0, s6
    v_mfma_f32_32x32x16_bf16 v[80:95], v[128:131], v[124:127], v[80:95]
    s_waitcnt vmcnt(4) lgkmcnt(5)
    s_barrier
    v_mfma_f32_32x32x16_bf16 v[64:79], v[96:99], v[100:103], v[64:79]
    s_sub_u32 s43, s43, 1
    s_cmp_eq_u32 s43, 0
    s_cselect_b32 s7, 4294937728, s31
    v_add_u32 v194, s7, v194
    ds_read_b64_tr_b16 v[120:121], v190 offset:8192
    ds_read_b64_tr_b16 v[122:123], v191 offset:8192
    ds_read_b128 v[124:127], v194 offset:0
    ds_read_b64_tr_b16 v[128:129], v192 offset:8192
    ds_read_b64_tr_b16 v[130:131], v193 offset:8192
    s_add_u32 m0, s27, 49152
    s_add_u32 s6, s25, s26
    buffer_load_dwordx4 v3, s[12:15], s25 offen lds
    s_cmp_eq_u32 s6, s42
    s_cselect_b32 s25, 0, s6
    v_mfma_f32_32x32x16_bf16 v[80:95], v[104:107], v[100:103], v[80:95]
    s_waitcnt vmcnt(4) lgkmcnt(5)
    s_barrier
    v_mfma_f32_32x32x16_bf16 v[64:79], v[108:111], v[112:115], v[64:79]
    ds_read_b64_tr_b16 v[96:97], v190 offset:16384
    ds_read_b64_tr_b16 v[98:99], v191 offset:16384
    ds_read_b128 v[100:103], v194 offset:1056
    ds_read_b64_tr_b16 v[104:105], v192 offset:16384
    ds_read_b64_tr_b16 v[106:107], v193 offset:16384
    s_add_u32 m0, s27, 0
    s_add_u32 s6, s25, s26
    buffer_load_dwordx4 v3, s[12:15], s25 offen lds
    s_cmp_eq_u32 s6, s42
    s_cselect_b32 s25, 0, s6
    v_mfma_f32_32x32x16_bf16 v[80:95], v[116:119], v[112:115], v[80:95]
    s_waitcnt vmcnt(4) lgkmcnt(5)
    s_barrier
    v_mfma_f32_32x32x16_bf16 v[64:79], v[120:123], v[124:127], v[64:79]
    ds_read_b64_tr_b16 v[108:109], v190 offset:24576
    ds_read_b64_tr_b16 v[110:111], v191 offset:24576
    ds_read_b128 v[112:115], v194 offset:2112
    ds_read_b64_tr_b16 v[116:117], v192 offset:24576
    ds_read_b64_tr_b16 v[118:119], v193 offset:24576
    s_add_u32 m0, s27, 8192
    s_add_u32 s6, s25, s26
    buffer_load_dwordx4 v3, s[12:15], s25 offen lds
    s_cmp_eq_u32 s6, s42
    s_cselect_b32 s25, 0, s6
    v_mfma_f32_32x32x16_bf16 v[80:95], v[128:131], v[124:127], v[80:95]
    v_lshlrev_b32 v164, 16, v56
    v_and_b32 v165, 0xffff0000, v56
    v_lshlrev_b32 v166, 16, v57
    v_and_b32 v167, 0xffff0000, v57
    v_lshlrev_b32 v168, 16, v58
    v_and_b32 v169, 0xffff0000, v58
    v_lshlrev_b32 v170, 16, v59
    v_and_b32 v171, 0xffff0000, v59
    v_lshlrev_b32 v172, 16, v60
    v_and_b32 v173, 0xffff0000, v60
    v_lshlrev_b32 v174, 16, v61
    v_and_b32 v175, 0xffff0000, v61
    v_lshlrev_b32 v176, 16, v62
    v_and_b32 v177, 0xffff0000, v62
    v_lshlrev_b32 v178, 16, v63
    v_and_b32 v179, 0xffff0000, v63
    s_mov_b32 s6, 0x3fb8aa3b
    v_pk_mul_f32 v[164:165], v[164:165], s[6:7] op_sel_hi:[1,0]
    v_pk_mul_f32 v[166:167], v[166:167], s[6:7] op_sel_hi:[1,0]
    v_pk_mul_f32 v[168:169], v[168:169], s[6:7] op_sel_hi:[1,0]
    v_pk_mul_f32 v[170:171], v[170:171], s[6:7] op_sel_hi:[1,0]
    v_pk_mul_f32 v[172:173], v[172:173], s[6:7] op_sel_hi:[1,0]
    v_pk_mul_f32 v[174:175], v[174:175], s[6:7] op_sel_hi:[1,0]
    v_pk_mul_f32 v[176:177], v[176:177], s[6:7] op_sel_hi:[1,0]
    v_pk_mul_f32 v[178:179], v[178:179], s[6:7] op_sel_hi:[1,0]
    s_waitcnt vmcnt(4) lgkmcnt(5)
    s_barrier
    v_mfma_f32_32x32x16_bf16 v[64:79], v[96:99], v[100:103], v[64:79]
    ds_read_b64_tr_b16 v[120:121], v190 offset:32768
    ds_read_b64_tr_b16 v[122:123], v191 offset:32768
    ds_read_b128 v[124:127], v194 offset:3168
    ds_read_b64_tr_b16 v[128:129], v192 offset:32768
    ds_read_b64_tr_b16 v[130:131], v193 offset:32768
    s_add_u32 m0, s27, 16384
    s_add_u32 s6, s25, s26
    buffer_load_dwordx4 v3, s[12:15], s25 offen lds
    s_cmp_eq_u32 s6, s42
    s_cselect_b32 s25, 0, s6
    v_mfma_f32_32x32x16_bf16 v[80:95], v[104:107], v[100:103], v[80:95]
    s_waitcnt vmcnt(4) lgkmcnt(5)
    s_barrier
    v_mfma_f32_32x32x16_bf16 v[64:79], v[108:111], v[112:115], v[64:79]
    s_sub_u32 s43, s43, 1
    s_cmp_eq_u32 s43, 0
    s_cselect_b32 s7, 4294937728, s31
    v_add_u32 v194, s7, v194
    ds_read_b64_tr_b16 v[96:97], v190 offset:40960
    ds_read_b64_tr_b16 v[98:99], v191 offset:40960
    ds_read_b128 v[100:103], v194 offset:0
    ds_read_b64_tr_b16 v[104:105], v192 offset:40960
    ds_read_b64_tr_b16 v[106:107], v193 offset:40960
    s_add_u32 m0, s27, 24576
    s_add_u32 s6, s25, s26
    buffer_load_dwordx4 v3, s[12:15], s25 offen lds
    s_cmp_eq_u32 s6, s42
    s_cselect_b32 s25, 0, s6
    v_mfma_f32_32x32x16_bf16 v[80:95], v[116:119], v[112:115], v[80:95]
    s_waitcnt vmcnt(4) lgkmcnt(5)
    s_barrier
    v_mfma_f32_32x32x16_bf16 v[64:79], v[120:123], v[124:127], v[64:79]
    ds_read_b64_tr_b16 v[108:109], v190 offset:49152
    ds_read_b64_tr_b16 v[110:111], v191 offset:49152
    ds_read_b128 v[112:115], v194 offset:1056
    ds_read_b64_tr_b16 v[116:117], v192 offset:49152
    ds_read_b64_tr_b16 v[118:119], v193 offset:49152
    s_add_u32 m0, s27, 32768
    s_add_u32 s6, s25, s26
    buffer_load_dwordx4 v3, s[12:15], s25 offen lds
    s_cmp_eq_u32 s6, s42
    s_cselect_b32 s25, 0, s6
    v_mfma_f32_32x32x16_bf16 v[80:95], v[128:131], v[124:127], v[80:95]
    s_waitcnt vmcnt(4) lgkmcnt(5)
    s_barrier
    v_mfma_f32_32x32x16_bf16 v[64:79], v[96:99], v[100:103], v[64:79]
    ds_read_b64_tr_b16 v[120:121], v190 offset:0
    ds_read_b64_tr_b16 v[122:123], v191 offset:0
    ds_read_b128 v[124:127], v194 offset:2112
    ds_read_b64_tr_b16 v[128:129], v192 offset:0
    ds_read_b64_tr_b16 v[130:131], v193 offset:0
    s_add_u32 m0, s27, 40960
    s_add_u32 s6, s25, s26
    buffer_load_dwordx4 v3, s[12:15], s25 offen lds
    s_cmp_eq_u32 s6, s42
    s_cselect_b32 s25, 0, s6
    v_mfma_f32_32x32x16_bf16 v[80:95], v[104:107], v[100:103], v[80:95]
    s_waitcnt vmcnt(4) lgkmcnt(5)
    s_barrier
    v_mfma_f32_32x32x16_bf16 v[64:79], v[108:111], v[112:115], v[64:79]
    ds_read_b64_tr_b16 v[96:97], v190 offset:8192
    ds_read_b64_tr_b16 v[98:99], v191 offset:8192
    ds_read_b128 v[100:103], v194 offset:3168
    ds_read_b64_tr_b16 v[104:105], v192 offset:8192
    ds_read_b64_tr_b16 v[106:107], v193 offset:8192
    s_add_u32 m0, s27, 49152
    s_add_u32 s6, s25, s26
    buffer_load_dwordx4 v3, s[12:15], s25 offen lds
    s_cmp_eq_u32 s6, s42
    s_cselect_b32 s25, 0, s6
    v_mfma_f32_32x32x16_bf16 v[80:95], v[116:119], v[112:115], v[80:95]
    s_waitcnt vmcnt(4) lgkmcnt(5)
    s_barrier
    v_mfma_f32_32x32x16_bf16 v[64:79], v[120:123], v[124:127], v[64:79]
    s_sub_u32 s43, s43, 1
    s_cmp_eq_u32 s43, 0
    s_cselect_b32 s7, 4294937728, s31
    v_add_u32 v194, s7, v194
    ds_read_b64_tr_b16 v[108:109], v190 offset:16384
    ds_read_b64_tr_b16 v[110:111], v191 offset:16384
    ds_read_b128 v[112:115], v194 offset:0
    ds_read_b64_tr_b16 v[116:117], v192 offset:16384
    ds_read_b64_tr_b16 v[118:119], v193 offset:16384
    s_add_u32 m0, s27, 0
    s_add_u32 s6, s25, s26
    buffer_load_dwordx4 v3, s[12:15], s25 offen lds
    s_cmp_eq_u32 s6, s42
    s_cselect_b32 s25, 0, s6
    v_mfma_f32_32x32x16_bf16 v[80:95], v[128:131], v[124:127], v[80:95]
    s_waitcnt vmcnt(4) lgkmcnt(5)
    s_barrier
    v_mfma_f32_32x32x16_bf16 v[64:79], v[96:99], v[100:103], v[64:79]
    ds_read_b64_tr_b16 v[120:121], v190 offset:24576
    ds_read_b64_tr_b16 v[122:123], v191 offset:24576
    ds_read_b128 v[124:127], v194 offset:1056
    ds_read_b64_tr_b16 v[128:129], v192 offset:24576
    ds_read_b64_tr_b16 v[130:131], v193 offset:24576
    s_add_u32 m0, s27, 8192
    s_add_u32 s6, s25, s26
    buffer_load_dwordx4 v3, s[12:15], s25 offen lds
    s_cmp_eq_u32 s6, s42
    s_cselect_b32 s25, 0, s6
    v_mfma_f32_32x32x16_bf16 v[80:95], v[104:107], v[100:103], v[80:95]
    s_waitcnt vmcnt(4) lgkmcnt(5)
    s_barrier
    v_mfma_f32_32x32x16_bf16 v[64:79], v[108:111], v[112:115], v[64:79]
    ds_read_b64_tr_b16 v[96:97], v190 offset:32768
    ds_read_b64_tr_b16 v[98:99], v191 offset:32768
    ds_read_b128 v[100:103], v194 offset:2112
    ds_read_b64_tr_b16 v[104:105], v192 offset:32768
    ds_read_b64_tr_b16 v[106:107], v193 offset:32768
    s_add_u32 m0, s27, 16384
    s_add_u32 s6, s25, s26
    buffer_load_dwordx4 v3, s[12:15], s25 offen lds
    s_cmp_eq_u32 s6, s42
    s_cselect_b32 s25, 0, s6
    v_mfma_f32_32x32x16_bf16 v[80:95], v[116:119], v[112:115], v[80:95]
    s_waitcnt vmcnt(4) lgkmcnt(5)
    s_barrier
    v_mfma_f32_32x32x16_bf16 v[64:79], v[120:123], v[124:127], v[64:79]
    ds_read_b64_tr_b16 v[108:109], v190 offset:40960
    ds_read_b64_tr_b16 v[110:111], v191 offset:40960
    ds_read_b128 v[112:115], v194 offset:3168
    ds_read_b64_tr_b16 v[116:117], v192 offset:40960
    ds_read_b64_tr_b16 v[118:119], v193 offset:40960
    s_add_u32 m0, s27, 24576
    s_add_u32 s6, s25, s26
    buffer_load_dwordx4 v3, s[12:15], s25 offen lds
    s_cmp_eq_u32 s6, s42
    s_cselect_b32 s25, 0, s6
    v_mfma_f32_32x32x16_bf16 v[80:95], v[128:131], v[124:127], v[80:95]
    s_waitcnt vmcnt(4) lgkmcnt(5)
    s_barrier
    v_mfma_f32_32x32x16_bf16 v[64:79], v[96:99], v[100:103], v[64:79]
    s_sub_u32 s43, s43, 1
    s_cmp_eq_u32 s43, 0
    s_cselect_b32 s7, 4294937728, s31
    v_add_u32 v194, s7, v194
    ds_read_b64_tr_b16 v[120:121], v190 offset:49152
    ds_read_b64_tr_b16 v[122:123], v191 offset:49152
    ds_read_b128 v[124:127], v194 offset:0
    ds_read_b64_tr_b16 v[128:129], v192 offset:49152
    ds_read_b64_tr_b16 v[130:131], v193 offset:49152
    s_add_u32 m0, s27, 32768
    s_add_u32 s6, s25, s26
    buffer_load_dwordx4 v3, s[12:15], s25 offen lds
    s_cmp_eq_u32 s6, s42
    s_cselect_b32 s25, 0, s6
    v_mfma_f32_32x32x16_bf16 v[80:95], v[104:107], v[100:103], v[80:95]
    buffer_load_dwordx4 v[24:27], v4, s[20:23], s83 offen sc1
    s_waitcnt vmcnt(5) lgkmcnt(5)
    s_barrier
    v_mfma_f32_32x32x16_bf16 v[64:79], v[108:111], v[112:115], v[64:79]
    ds_read_b64_tr_b16 v[96:97], v190 offset:0
    ds_read_b64_tr_b16 v[98:99], v191 offset:0
    ds_read_b128 v[100:103], v194 offset:1056
    ds_read_b64_tr_b16 v[104:105], v192 offset:0
    ds_read_b64_tr_b16 v[106:107], v193 offset:0
    s_add_u32 m0, s27, 40960
    s_add_u32 s6, s25, s26
    buffer_load_dwordx4 v3, s[12:15], s25 offen lds
    s_cmp_eq_u32 s6, s42
    s_cselect_b32 s25, 0, s6
    v_mfma_f32_32x32x16_bf16 v[80:95], v[116:119], v[112:115], v[80:95]
    s_waitcnt vmcnt(5) lgkmcnt(5)
    s_barrier
    v_mfma_f32_32x32x16_bf16 v[64:79], v[120:123], v[124:127], v[64:79]
    ds_read_b64_tr_b16 v[108:109], v190 offset:8192
    ds_read_b64_tr_b16 v[110:111], v191 offset:8192
    ds_read_b128 v[112:115], v194 offset:2112
    ds_read_b64_tr_b16 v[116:117], v192 offset:8192
    ds_read_b64_tr_b16 v[118:119], v193 offset:8192
    s_add_u32 m0, s27, 49152
    s_add_u32 s6, s25, s26
    buffer_load_dwordx4 v3, s[12:15], s25 offen lds
    s_cmp_eq_u32 s6, s42
    s_cselect_b32 s25, 0, s6
    v_mfma_f32_32x32x16_bf16 v[80:95], v[128:131], v[124:127], v[80:95]
    s_waitcnt vmcnt(5) lgkmcnt(5)
    s_barrier
    v_mfma_f32_32x32x16_bf16 v[64:79], v[96:99], v[100:103], v[64:79]
    ds_read_b64_tr_b16 v[120:121], v190 offset:16384
    ds_read_b64_tr_b16 v[122:123], v191 offset:16384
    ds_read_b128 v[124:127], v194 offset:3168
    ds_read_b64_tr_b16 v[128:129], v192 offset:16384
    ds_read_b64_tr_b16 v[130:131], v193 offset:16384
    s_add_u32 m0, s27, 0
    s_add_u32 s6, s25, s26
    buffer_load_dwordx4 v3, s[12:15], s25 offen lds
    s_cmp_eq_u32 s6, s42
    s_cselect_b32 s25, 0, s6
    v_mfma_f32_32x32x16_bf16 v[80:95], v[104:107], v[100:103], v[80:95]
    s_waitcnt vmcnt(5) lgkmcnt(5)
    s_barrier
    v_mfma_f32_32x32x16_bf16 v[64:79], v[108:111], v[112:115], v[64:79]
    s_sub_u32 s43, s43, 1
    s_cmp_eq_u32 s43, 0
    s_cselect_b32 s7, 4294937728, s31
    v_add_u32 v194, s7, v194
    ds_read_b64_tr_b16 v[96:97], v190 offset:24576
    ds_read_b64_tr_b16 v[98:99], v191 offset:24576
    ds_read_b128 v[100:103], v194 offset:0
    ds_read_b64_tr_b16 v[104:105], v192 offset:24576
    ds_read_b64_tr_b16 v[106:107], v193 offset:24576
    s_add_u32 m0, s27, 8192
    s_add_u32 s6, s25, s26
    buffer_load_dwordx4 v3, s[12:15], s25 offen lds
    s_cmp_eq_u32 s6, s42
    s_cselect_b32 s25, 0, s6
    v_mfma_f32_32x32x16_bf16 v[80:95], v[116:119], v[112:115], v[80:95]
    s_waitcnt vmcnt(5) lgkmcnt(5)
    s_barrier
    v_mfma_f32_32x32x16_bf16 v[64:79], v[120:123], v[124:127], v[64:79]
    ds_read_b64_tr_b16 v[108:109], v190 offset:32768
    ds_read_b64_tr_b16 v[110:111], v191 offset:32768
    ds_read_b128 v[112:115], v194 offset:1056
    ds_read_b64_tr_b16 v[116:117], v192 offset:32768
    ds_read_b64_tr_b16 v[118:119], v193 offset:32768
    s_add_u32 m0, s27, 16384
    s_add_u32 s6, s25, s26
    buffer_load_dwordx4 v3, s[12:15], s25 offen lds
    s_cmp_eq_u32 s6, s42
    s_cselect_b32 s25, 0, s6
    v_mfma_f32_32x32x16_bf16 v[80:95], v[128:131], v[124:127], v[80:95]
    s_waitcnt vmcnt(4) lgkmcnt(5)
    s_barrier
    v_mfma_f32_32x32x16_bf16 v[64:79], v[96:99], v[100:103], v[64:79]
    ds_read_b64_tr_b16 v[120:121], v190 offset:40960
    ds_read_b64_tr_b16 v[122:123], v191 offset:40960
    ds_read_b128 v[124:127], v194 offset:2112
    ds_read_b64_tr_b16 v[128:129], v192 offset:40960
    ds_read_b64_tr_b16 v[130:131], v193 offset:40960
    s_add_u32 m0, s27, 24576
    s_add_u32 s6, s25, s26
    buffer_load_dwordx4 v3, s[12:15], s25 offen lds
    s_cmp_eq_u32 s6, s42
    s_cselect_b32 s25, 0, s6
    v_mfma_f32_32x32x16_bf16 v[80:95], v[104:107], v[100:103], v[80:95]
    v_cmp_ne_u32 vcc, s56, v24
    v_cmp_ne_u32 s[34:35], s56, v26
    s_or_b64 vcc, vcc, s[34:35]
    s_mov_b32 s92, s54
    s_mov_b32 s93, s55
    s_mov_b32 s94, 16777216
    s_mov_b32 s95, 0x00020000
    s_mul_i32 s90, s3, 8192
    s_add_u32 s91, s90, 2097152
    s_cmp_eq_u64 vcc, 0
    s_cselect_b32 s84, 1, 0
    s_cselect_b32 s94, s94, 0
    s_cselect_b32 s90, s90, 0x30000
    s_add_u32 m0, s90, 0
    s_nop 0
    buffer_load_dwordx4 v4, s[92:95], s91 offen sc1 lds
    s_add_u32 s91, s91, 1024
    s_add_u32 m0, s90, 1024
    s_nop 0
    buffer_load_dwordx4 v4, s[92:95], s91 offen sc1 lds
    s_add_u32 s91, s91, 1024
    s_waitcnt vmcnt(6) lgkmcnt(5)
    s_barrier
    v_mfma_f32_32x32x16_bf16 v[64:79], v[108:111], v[112:115], v[64:79]
    ds_read_b64_tr_b16 v[96:97], v190 offset:49152
    ds_read_b64_tr_b16 v[98:99], v191 offset:49152
    ds_read_b128 v[100:103], v194 offset:3168
    ds_read_b64_tr_b16 v[104:105], v192 offset:49152
    ds_read_b64_tr_b16 v[106:107], v193 offset:49152
    v_mfma_f32_32x32x16_bf16 v[80:95], v[116:119], v[112:115], v[80:95]
    s_add_u32 m0, s90, 2048
    s_nop 0
    buffer_load_dwordx4 v4, s[92:95], s91 offen sc1 lds
    s_add_u32 s91, s91, 1024
    s_add_u32 m0, s90, 3072
    s_nop 0
    buffer_load_dwordx4 v4, s[92:95], s91 offen sc1 lds
    s_add_u32 s91, s91, 1024
    s_waitcnt vmcnt(7) lgkmcnt(5)
    s_barrier
    v_mfma_f32_32x32x16_bf16 v[64:79], v[120:123], v[124:127], v[64:79]
    s_sub_u32 s43, s43, 1
    s_cmp_eq_u32 s43, 0
    s_cselect_b32 s7, 4294937728, s31
    v_add_u32 v194, s7, v194
    ds_read_b64_tr_b16 v[108:109], v190 offset:0
    ds_read_b64_tr_b16 v[110:111], v191 offset:0
    ds_read_b128 v[112:115], v194 offset:0
    ds_read_b64_tr_b16 v[116:117], v192 offset:0
    ds_read_b64_tr_b16 v[118:119], v193 offset:0
    v_mfma_f32_32x32x16_bf16 v[80:95], v[128:131], v[124:127], v[80:95]
    s_add_u32 m0, s90, 4096
    s_nop 0
    buffer_load_dwordx4 v4, s[92:95], s91 offen sc1 lds
    s_add_u32 s91, s91, 1024
    s_add_u32 m0, s90, 5120
    s_nop 0
    buffer_load_dwordx4 v4, s[92:95], s91 offen sc1 lds
    s_add_u32 s91, s91, 1024
    s_waitcnt vmcnt(8) lgkmcnt(5)
    s_barrier
    v_mfma_f32_32x32x16_bf16 v[64:79], v[96:99], v[100:103], v[64:79]
    ds_read_b64_tr_b16 v[120:121], v190 offset:8192
    ds_read_b64_tr_b16 v[122:123], v191 offset:8192
    ds_read_b128 v[124:127], v194 offset:1056
    ds_read_b64_tr_b16 v[128:129], v192 offset:8192
    ds_read_b64_tr_b16 v[130:131], v193 offset:8192
    v_mfma_f32_32x32x16_bf16 v[80:95], v[104:107], v[100:103], v[80:95]
    s_add_u32 m0, s90, 6144
    s_nop 0
    buffer_load_dwordx4 v4, s[92:95], s91 offen sc1 lds
    s_add_u32 s91, s91, 1024
    s_add_u32 m0, s90, 7168
    s_nop 0
    buffer_load_dwordx4 v4, s[92:95], s91 offen sc1 lds
    s_add_u32 s91, s91, 1024
    s_waitcnt vmcnt(9) lgkmcnt(5)
    s_barrier
    v_mfma_f32_32x32x16_bf16 v[64:79], v[108:111], v[112:115], v[64:79]
    ds_read_b64_tr_b16 v[96:97], v190 offset:16384
    ds_read_b64_tr_b16 v[98:99], v191 offset:16384
    ds_read_b128 v[100:103], v194 offset:2112
    ds_read_b64_tr_b16 v[104:105], v192 offset:16384
    ds_read_b64_tr_b16 v[106:107], v193 offset:16384
    v_mfma_f32_32x32x16_bf16 v[80:95], v[116:119], v[112:115], v[80:95]
    v_max_f32 v25, v25, v27
    s_nop 1
    v_max_f32_dpp v25, v25, v25 row_ror:8 row_mask:0xf bank_mask:0xf
    s_nop 1
    v_max_f32_dpp v25, v25, v25 row_ror:4 row_mask:0xf bank_mask:0xf
    s_nop 1
    v_max_f32_dpp v25, v25, v25 row_ror:2 row_mask:0xf bank_mask:0xf
    s_nop 1
    v_max_f32_dpp v25, v25, v25 row_ror:1 row_mask:0xf bank_mask:0xf
    v_mov_b32 v28, v25
    s_nop 1
    v_permlane16_swap_b32 v25, v28
    s_nop 1
    v_max_f32 v25, v25, v28
    v_mov_b32 v28, v25
    s_nop 1
    v_permlane32_swap_b32 v25, v28
    s_nop 1
    v_max_f32 v25, v25, v28
    s_waitcnt vmcnt(8) lgkmcnt(5)
    s_barrier
    v_mfma_f32_32x32x16_bf16 v[64:79], v[120:123], v[124:127], v[64:79]
    ds_read_b64_tr_b16 v[108:109], v190 offset:24576
    ds_read_b64_tr_b16 v[110:111], v191 offset:24576
    ds_read_b128 v[112:115], v194 offset:3168
    ds_read_b64_tr_b16 v[116:117], v192 offset:24576
    ds_read_b64_tr_b16 v[118:119], v193 offset:24576
    v_mfma_f32_32x32x16_bf16 v[80:95], v[128:131], v[124:127], v[80:95]
    v_mov_b32 v40, -1
    v_mov_b32 v41, -1
    v_mov_b32 v42, -1
    v_mov_b32 v43, -1
    buffer_store_dwordx4 v[40:43], v4, s[20:23], s68 offen sc1
    s_waitcnt lgkmcnt(5)
    v_mfma_f32_32x32x16_bf16 v[64:79], v[96:99], v[100:103], v[64:79]
    v_mfma_f32_32x32x16_bf16 v[80:95], v[104:107], v[100:103], v[80:95]
    s_waitcnt lgkmcnt(0)
    v_mfma_f32_32x32x16_bf16 v[64:79], v[108:111], v[112:115], v[64:79]
    v_mfma_f32_32x32x16_bf16 v[80:95], v[116:119], v[112:115], v[80:95]
    v_mul_f32 v18, 0x3eb8aa3b, v22
    s_mul_i32 s6, s3, 3072
    s_add_u32 s6, s6, 147456
    v_add_u32 v2, s6, v4
    s_nop 6
    v_pk_mul_f32 v[64:65], v[64:65], v[18:19] op_sel_hi:[1,0]
    v_pk_mul_f32 v[66:67], v[66:67], v[18:19] op_sel_hi:[1,0]
    v_pk_mul_f32 v[68:69], v[68:69], v[18:19] op_sel_hi:[1,0]
    v_pk_mul_f32 v[70:71], v[70:71], v[18:19] op_sel_hi:[1,0]
    v_pk_mul_f32 v[72:73], v[72:73], v[18:19] op_sel_hi:[1,0]
    v_pk_mul_f32 v[74:75], v[74:75], v[18:19] op_sel_hi:[1,0]
    v_pk_mul_f32 v[76:77], v[76:77], v[18:19] op_sel_hi:[1,0]
    v_pk_mul_f32 v[78:79], v[78:79], v[18:19] op_sel_hi:[1,0]
    v_cvt_pk_bf16_f32 v8, v64, v65
    v_cvt_pk_bf16_f32 v9, v66, v67
    v_cvt_pk_bf16_f32 v10, v68, v69
    v_cvt_pk_bf16_f32 v11, v70, v71
    v_cvt_pk_bf16_f32 v12, v72, v73
    v_cvt_pk_bf16_f32 v13, v74, v75
    v_cvt_pk_bf16_f32 v14, v76, v77
    v_cvt_pk_bf16_f32 v15, v78, v79
    ds_write_b128 v2, v[8:11]
    ds_write_b128 v2, v[12:15] offset:1024
    s_cmp_eq_u32 s84, 1
    s_cbranch_scc1 L_kvdone
    s_mov_b32 s7, 200000
L_pollkv:
    buffer_load_dwordx4 v[24:27], v4, s[20:23], s83 offen sc1
    s_waitcnt vmcnt(0)
    v_cmp_ne_u32 vcc, s56, v24
    v_cmp_ne_u32 s[34:35], s56, v26
    s_or_b64 vcc, vcc, s[34:35]
    s_cbranch_vccz L_kvok
    s_sub_u32 s7, s7, 1
    s_cmp_lg_u32 s7, 0
    s_cbranch_scc1 L_pollkv
L_kvok:
    s_mov_b32 s92, s54
    s_mov_b32 s93, s55
    s_mov_b32 s94, 16777216
    s_mov_b32 s95, 0x00020000
    s_mul_i32 s90, s3, 8192
    s_add_u32 s91, s90, 2097152
    s_add_u32 m0, s90, 0
    s_nop 0
    buffer_load_dwordx4 v4, s[92:95], s91 offen sc1 lds
    s_add_u32 s91, s91, 1024
    s_add_u32 m0, s90, 1024
    s_nop 0
    buffer_load_dwordx4 v4, s[92:95], s91 offen sc1 lds
    s_add_u32 s91, s91, 1024
    s_add_u32 m0, s90, 2048
    s_nop 0
    buffer_load_dwordx4 v4, s[92:95], s91 offen sc1 lds
    s_add_u32 s91, s91, 1024
    s_add_u32 m0, s90, 3072
    s_nop 0
    buffer_load_dwordx4 v4, s[92:95], s91 offen sc1 lds
    s_add_u32 s91, s91, 1024
    s_add_u32 m0, s90, 4096
    s_nop 0
    buffer_load_dwordx4 v4, s[92:95], s91 offen sc1 lds
    s_add_u32 s91, s91, 1024
    s_add_u32 m0, s90, 5120
    s_nop 0
    buffer_load_dwordx4 v4, s[92:95], s91 offen sc1 lds
    s_add_u32 s91, s91, 1024
    s_add_u32 m0, s90, 6144
    s_nop 0
    buffer_load_dwordx4 v4, s[92:95], s91 offen sc1 lds
    s_add_u32 s91, s91, 1024
    s_add_u32 m0, s90, 7168
    s_nop 0
    buffer_load_dwordx4 v4, s[92:95], s91 offen sc1 lds
    s_add_u32 s91, s91, 1024
    v_max_f32 v25, v25, v27
    s_nop 1
    v_max_f32_dpp v25, v25, v25 row_ror:8 row_mask:0xf bank_mask:0xf
    s_nop 1
    v_max_f32_dpp v25, v25, v25 row_ror:4 row_mask:0xf bank_mask:0xf
    s_nop 1
    v_max_f32_dpp v25, v25, v25 row_ror:2 row_mask:0xf bank_mask:0xf
    s_nop 1
    v_max_f32_dpp v25, v25, v25 row_ror:1 row_mask:0xf bank_mask:0xf
    v_mov_b32 v28, v25
    s_nop 1
    v_permlane16_swap_b32 v25, v28
    s_nop 1
    v_max_f32 v25, v25, v28
    v_mov_b32 v28, v25
    s_nop 1
    v_permlane32_swap_b32 v25, v28
    s_nop 1
    v_max_f32 v25, v25, v28
    s_waitcnt vmcnt(0)
L_kvdone:
    v_dot2_f32_bf16 v28, v8, v8, 0
    v_dot2_f32_bf16 v28, v9, v9, v28
    v_dot2_f32_bf16 v28, v10, v10, v28
    v_dot2_f32_bf16 v28, v11, v11, v28
    v_dot2_f32_bf16 v29, v12, v12, 0
    v_dot2_f32_bf16 v29, v13, v13, v29
    v_dot2_f32_bf16 v29, v14, v14, v29
    v_dot2_f32_bf16 v29, v15, v15, v29
    s_lshl_b32 s6, s3, 2
    s_add_u32 s6, s6, 160000
    v_mov_b32 v24, s6
    v_mov_b32 v30, v28
    v_mov_b32 v31, v29
    s_nop 1
    v_permlane32_swap_b32 v28, v30
    v_permlane32_swap_b32 v29, v31
    s_nop 1
    v_add_f32 v28, v28, v30
    v_add_f32 v29, v29, v31
    v_mul_f32 v28, v28, v25
    v_mul_f32 v29, v29, v25
    s_mov_b32 s6, 0x45610000
    v_cmp_ge_f32 vcc, s6, v28
    v_cmp_ge_f32 s[34:35], s6, v29
    s_and_b64 vcc, vcc, s[34:35]
    s_cmp_eq_u64 vcc, -1
    s_cselect_b32 s6, 1, 0
    v_mov_b32 v25, s6
    ds_write_b32 v24, v25
    s_branch L_b2
L_b1x:
    s_waitcnt vmcnt(0) lgkmcnt(0)
    s_mul_i32 s56, s56, 0x9E3779B1
    s_add_u32 s56, s56, 0x85EBCA6B
    s_cmp_eq_u32 s24, 2
    s_cbranch_scc1 L_kv
    s_barrier
    v_mov_b32 v40, -1
    v_mov_b32 v41, -1
    v_mov_b32 v42, -1
    v_mov_b32 v43, -1
    buffer_store_dwordx4 v[40:43], v4, s[20:23], s68 offen sc1
    s_waitcnt lgkmcnt(0)
    s_barrier
    s_barrier
    s_barrier
    s_barrier
    s_barrier
    s_barrier
    s_barrier
    s_barrier
    s_barrier
    s_barrier
    s_barrier
    s_barrier
    s_barrier
    s_barrier
    s_barrier
    s_barrier
    s_barrier
    s_barrier
    s_barrier
    s_barrier
    s_barrier
    s_barrier
    s_barrier
    s_barrier
    s_barrier
    s_barrier
    s_barrier
    s_barrier
    s_barrier
    s_barrier
    s_waitcnt vmcnt(0)
    s_branch L_b2
L_kv:
    s_setprio 2
    v_lshrrev_b32 v10, 4, v1
    v_and_b32 v11, 15, v1
    v_lshlrev_b32 v6, 8, v10
    v_bfe_u32 v8, v1, 2, 2
    v_lshl_add_u32 v6, v8, 5, v6
    v_and_b32 v8, 3, v1
    v_lshl_add_u32 v6, v8, 3, v6
    s_and_b32 s29, s5, 1
    s_mul_i32 s6, s29, 33792
    s_add_u32 s6, s6, 32768
    v_mul_u32_u24 v5, 528, v10
    v_lshl_add_u32 v5, v11, 4, v5
    v_add_u32 v5, s6, v5
    s_lshl_b32 s6, s29, 7
    s_add_u32 s6, s6, 159744
    v_lshl_add_u32 v8, v11, 2, s6
    v_lshlrev_b32 v9, 5, v11
    v_lshl_add_u32 v9, v10, 3, v9
    v_add_u32 v9, 16384, v9
    v_lshrrev_b32 v7, 5, v1
    v_lshlrev_b32 v7, 2, v7
    v_bfe_u32 v16, v1, 4, 1
    v_add_u32 v7, v7, v16
    v_lshlrev_b32 v7, 2, v7
    v_bfe_u32 v16, v1, 2, 2
    v_add_u32 v7, v7, v16
    v_lshlrev_b32 v7, 5, v7
    v_and_b32 v16, 3, v1
    v_lshl_add_u32 v7, v16, 3, v7
    v_add_u32 v7, 16384, v7
    s_lshl_b32 s6, s4, 1
    s_add_u32 s6, s6, s29
    s_mul_i32 s30, s6, 2112
    s_add_u32 s30, s30, 2097152
    s_lshl_b32 s6, s4, 2
    s_add_u32 s6, s6, s28
    s_lshl_b32 s6, s6, 3
    s_add_u32 s31, s6, 528384
    v_bfe_u32 v16, v1, 4, 1
    v_lshrrev_b32 v17, 5, v1
    v_lshlrev_b32 v2, 4, v11
    v_lshl_add_u32 v3, v17, 8, v2
    v_lshl_add_u32 v3, v16, 9, v3
    v_mul_u32_u24 v16, 272, v16
    v_mul_u32_u24 v17, 544, v17
    v_add3_u32 v2, v2, v16, v17
    s_barrier
    ds_read_b64_tr_b16 v[96:97], v6 offset:0
    ds_read_b64_tr_b16 v[98:99], v6 offset:128
    ds_read_b128 v[160:163], v5 offset:0
    ds_read_b128 v[164:167], v5 offset:256
    ds_read_b64_tr_b16 v[100:101], v6 offset:1024
    ds_read_b64_tr_b16 v[102:103], v6 offset:1152
    ds_read_b128 v[168:171], v5 offset:2112
    ds_read_b128 v[172:175], v5 offset:2368
    ds_read_b64_tr_b16 v[104:105], v6 offset:2048
    ds_read_b64_tr_b16 v[106:107], v6 offset:2176
    ds_read_b128 v[176:179], v5 offset:4224
    ds_read_b128 v[180:183], v5 offset:4480
    s_waitcnt lgkmcnt(8)
    v_mfma_f32_16x16x32_bf16 v[64:67], v[96:99], v[160:163], 0
    v_mfma_f32_16x16x32_bf16 v[68:71], v[96:99], v[164:167], 0
    ds_read_b64_tr_b16 v[108:109], v6 offset:3072
    ds_read_b64_tr_b16 v[110:111], v6 offset:3200
    ds_read_b128 v[184:187], v5 offset:6336
    ds_read_b128 v[188:191], v5 offset:6592
    s_waitcnt lgkmcnt(8)
    v_mfma_f32_16x16x32_bf16 v[64:67], v[100:103], v[168:171], v[64:67]
    v_mfma_f32_16x16x32_bf16 v[68:71], v[100:103], v[172:175], v[68:71]
    ds_read_b64_tr_b16 v[112:113], v6 offset:4096
    ds_read_b64_tr_b16 v[114:115], v6 offset:4224
    ds_read_b128 v[160:163], v5 offset:8448
    ds_read_b128 v[164:167], v5 offset:8704
    s_waitcnt lgkmcnt(8)
    v_mfma_f32_16x16x32_bf16 v[64:67], v[104:107], v[176:179], v[64:67]
    v_mfma_f32_16x16x32_bf16 v[68:71], v[104:107], v[180:183], v[68:71]
    ds_read_b64_tr_b16 v[116:117], v6 offset:5120
    ds_read_b64_tr_b16 v[118:119], v6 offset:5248
    ds_read_b128 v[168:171], v5 offset:10560
    ds_read_b128 v[172:175], v5 offset:10816
    s_waitcnt lgkmcnt(8)
    v_mfma_f32_16x16x32_bf16 v[64:67], v[108:111], v[184:187], v[64:67]
    v_mfma_f32_16x16x32_bf16 v[68:71], v[108:111], v[188:191], v[68:71]
    ds_read_b64_tr_b16 v[120:121], v6 offset:6144
    ds_read_b64_tr_b16 v[122:123], v6 offset:6272
    ds_read_b128 v[176:179], v5 offset:12672
    ds_read_b128 v[180:183], v5 offset:12928
    s_waitcnt lgkmcnt(8)
    v_mfma_f32_16x16x32_bf16 v[64:67], v[112:115], v[160:163], v[64:67]
    v_mfma_f32_16x16x32_bf16 v[68:71], v[112:115], v[164:167], v[68:71]
    ds_read_b64_tr_b16 v[124:125], v6 offset:7168
    ds_read_b64_tr_b16 v[126:127], v6 offset:7296
    ds_read_b128 v[184:187], v5 offset:14784
    ds_read_b128 v[188:191], v5 offset:15040
    s_waitcnt lgkmcnt(8)
    v_mfma_f32_16x16x32_bf16 v[64:67], v[116:119], v[168:171], v[64:67]
    v_mfma_f32_16x16x32_bf16 v[68:71], v[116:119], v[172:175], v[68:71]
    ds_read_b64_tr_b16 v[128:129], v6 offset:8192
    ds_read_b64_tr_b16 v[130:131], v6 offset:8320
    ds_read_b128 v[160:163], v5 offset:16896
    ds_read_b128 v[164:167], v5 offset:17152
    s_waitcnt lgkmcnt(8)
    v_mfma_f32_16x16x32_bf16 v[64:67], v[120:123], v[176:179], v[64:67]
    v_mfma_f32_16x16x32_bf16 v[68:71], v[120:123], v[180:183], v[68:71]
    ds_read_b64_tr_b16 v[132:133], v6 offset:9216
    ds_read_b64_tr_b16 v[134:135], v6 offset:9344
    ds_read_b128 v[168:171], v5 offset:19008
    ds_read_b128 v[172:175], v5 offset:19264
    s_waitcnt lgkmcnt(8)
    v_mfma_f32_16x16x32_bf16 v[64:67], v[124:127], v[184:187], v[64:67]
    v_mfma_f32_16x16x32_bf16 v[68:71], v[124:127], v[188:191], v[68:71]
    ds_read_b64_tr_b16 v[136:137], v6 offset:10240
    ds_read_b64_tr_b16 v[138:139], v6 offset:10368
    ds_read_b128 v[176:179], v5 offset:21120
    ds_read_b128 v[180:183], v5 offset:21376
    s_waitcnt lgkmcnt(8)
    v_mfma_f32_16x16x32_bf16 v[64:67], v[128:131], v[160:163], v[64:67]
    v_mfma_f32_16x16x32_bf16 v[68:71], v[128:131], v[164:167], v[68:71]
    ds_read_b64_tr_b16 v[140:141], v6 offset:11264
    ds_read_b64_tr_b16 v[142:143], v6 offset:11392
    ds_read_b128 v[184:187], v5 offset:23232
    ds_read_b128 v[188:191], v5 offset:23488
    s_waitcnt lgkmcnt(8)
    v_mfma_f32_16x16x32_bf16 v[64:67], v[132:135], v[168:171], v[64:67]
    v_mfma_f32_16x16x32_bf16 v[68:71], v[132:135], v[172:175], v[68:71]
    ds_read_b64_tr_b16 v[144:145], v6 offset:12288
    ds_read_b64_tr_b16 v[146:147], v6 offset:12416
    ds_read_b128 v[160:163], v5 offset:25344
    ds_read_b128 v[164:167], v5 offset:25600
    s_waitcnt lgkmcnt(8)
    v_mfma_f32_16x16x32_bf16 v[64:67], v[136:139], v[176:179], v[64:67]
    v_mfma_f32_16x16x32_bf16 v[68:71], v[136:139], v[180:183], v[68:71]
    ds_read_b64_tr_b16 v[148:149], v6 offset:13312
    ds_read_b64_tr_b16 v[150:151], v6 offset:13440
    ds_read_b128 v[168:171], v5 offset:27456
    ds_read_b128 v[172:175], v5 offset:27712
    s_waitcnt lgkmcnt(8)
    v_mfma_f32_16x16x32_bf16 v[64:67], v[140:143], v[184:187], v[64:67]
    v_mfma_f32_16x16x32_bf16 v[68:71], v[140:143], v[188:191], v[68:71]
    ds_read_b64_tr_b16 v[152:153], v6 offset:14336
    ds_read_b64_tr_b16 v[154:155], v6 offset:14464
    ds_read_b128 v[176:179], v5 offset:29568
    ds_read_b128 v[180:183], v5 offset:29824
    s_waitcnt lgkmcnt(8)
    v_mfma_f32_16x16x32_bf16 v[64:67], v[144:147], v[160:163], v[64:67]
    v_mfma_f32_16x16x32_bf16 v[68:71], v[144:147], v[164:167], v[68:71]
    ds_read_b64_tr_b16 v[156:157], v6 offset:15360
    ds_read_b64_tr_b16 v[158:159], v6 offset:15488
    ds_read_b128 v[184:187], v5 offset:31680
    ds_read_b128 v[188:191], v5 offset:31936
    s_waitcnt lgkmcnt(8)
    v_mfma_f32_16x16x32_bf16 v[64:67], v[148:151], v[168:171], v[64:67]
    v_mfma_f32_16x16x32_bf16 v[68:71], v[148:151], v[172:175], v[68:71]
    s_waitcnt lgkmcnt(4)
    v_mfma_f32_16x16x32_bf16 v[64:67], v[152:155], v[176:179], v[64:67]
    v_mfma_f32_16x16x32_bf16 v[68:71], v[152:155], v[180:183], v[68:71]
    s_waitcnt lgkmcnt(0)
    v_mfma_f32_16x16x32_bf16 v[64:67], v[156:159], v[184:187], v[64:67]
    v_mfma_f32_16x16x32_bf16 v[68:71], v[156:159], v[188:191], v[68:71]
    ds_read_b32 v12, v8
    ds_read_b32 v16, v8 offset:64
    s_barrier
    s_waitcnt lgkmcnt(0)
    s_nop 3
    v_mul_f32 v64, v64, v12
    v_mul_f32 v65, v65, v12
    v_mul_f32 v66, v66, v12
    v_mul_f32 v67, v67, v12
    v_mul_f32 v68, v68, v16
    v_mul_f32 v69, v69, v16
    v_mul_f32 v70, v70, v16
    v_mul_f32 v71, v71, v16
    v_cvt_pk_bf16_f32 v72, v64, v65
    v_cvt_pk_bf16_f32 v73, v66, v67
    v_cvt_pk_bf16_f32 v74, v68, v69
    v_cvt_pk_bf16_f32 v75, v70, v71
    s_cmp_lt_u32 s5, 6
    s_cbranch_scc1 L_kv_k
    ds_write_b64 v9, v[72:73]
    ds_write_b64 v9, v[74:75] offset:512
    v_mul_u32_u24 v16, 272, v1
    v_mov_b32 v76, s57
    v_mov_b32 v77, s57
    v_mov_b32 v78, s57
    v_mov_b32 v79, s57
    s_mov_b64 exec, 15
    buffer_store_dwordx4 v[76:79], v16, s[20:23], s30 offen offset:1280 sc1
    s_mov_b64 exec, -1
    s_waitcnt lgkmcnt(0)
    ds_read_b64_tr_b16 v[72:73], v7
    ds_read_b64_tr_b16 v[74:75], v7 offset:256
    v_mov_b32 v19, 0
    s_waitcnt lgkmcnt(0)
    buffer_store_dwordx4 v[72:75], v2, s[20:23], s30 offen offset:1024 sc1
    s_branch L_kv_j
L_kv_k:
    v_permlane32_swap_b32 v72, v74
    v_permlane32_swap_b32 v73, v75
    s_nop 1
    buffer_store_dwordx4 v[72:75], v3, s[20:23], s30 offen sc1
    v_dot2_f32_bf16 v19, v72, v72, 0
    v_dot2_f32_bf16 v19, v73, v73, v19
    v_dot2_f32_bf16 v19, v74, v74, v19
    v_dot2_f32_bf16 v19, v75, v75, v19
    s_nop 2
    v_mov_b32 v18, v19
    s_nop 1
    v_permlane16_swap_b32 v18, v19
    s_nop 1
    v_add_f32 v19, v18, v19
    s_nop 1
    v_max_f32_dpp v19, v19, v19 row_ror:8 row_mask:0xf bank_mask:0xf
    s_nop 1
    v_max_f32_dpp v19, v19, v19 row_ror:4 row_mask:0xf bank_mask:0xf
    s_nop 1
    v_max_f32_dpp v19, v19, v19 row_ror:2 row_mask:0xf bank_mask:0xf
    s_nop 1
    v_max_f32_dpp v19, v19, v19 row_ror:1 row_mask:0xf bank_mask:0xf
    v_mov_b32 v18, v19
    s_nop 1
    v_permlane16_swap_b32 v19, v18
    s_nop 1
    v_max_f32 v19, v19, v18
    v_mov_b32 v18, v19
    s_nop 1
    v_permlane32_swap_b32 v19, v18
    s_nop 1
    v_max_f32 v19, v19, v18
L_kv_j:
    v_mov_b32 v18, s56
    v_mov_b32 v16, 0
    s_mov_b32 s6, s31
    s_mov_b32 s7, 29
L_kvw:
    s_barrier
    s_sub_u32 s7, s7, 1
    s_getreg_b32 s29, hwreg(HW_REG_IB_STS, 0, 4)
    s_cmp_eq_u32 s29, 0
    s_cbranch_scc1 L_kvp
    s_cmp_lg_u32 s7, 0
    s_cbranch_scc1 L_kvw
L_kvp:
    v_cmp_eq_u32 vcc, 0, v1
    s_and_saveexec_b64 s[34:35], vcc
    s_waitcnt vmcnt(0)
    buffer_store_dwordx2 v[18:19], v16, s[20:23], s6 offen sc1
    s_mov_b64 exec, s[34:35]
    s_setprio 0
    v_mov_b32 v40, -1
    v_mov_b32 v41, -1
    v_mov_b32 v42, -1
    v_mov_b32 v43, -1
    buffer_store_dwordx4 v[40:43], v4, s[20:23], s68 offen sc1
    s_cmp_eq_u32 s7, 0
    s_cbranch_scc1 L_kve
L_kvr:
    s_barrier
    s_sub_u32 s7, s7, 1
    s_cmp_lg_u32 s7, 0
    s_cbranch_scc1 L_kvr
L_kve:
    s_waitcnt vmcnt(0)
L_b2:
    v_mul_f32 v22, 0x3fb8aa3b, v22
    v_mul_f32 v20, 0x3fb8aa3b, v20
    s_mov_b32 s30, 0xbfb17218
    s_mov_b32 s31, 0xbfb17218
    v_mov_b32 v196, 0x3f317218
    v_mov_b32 v197, 0x3f317218
    s_cmp_eq_u32 s24, 1
    s_cbranch_scc0 L_npm
    s_nop 3
    v_pk_fma_f32 v[64:65], v[64:65], v[22:23], v[164:165] op_sel_hi:[1,0,1]
    v_pk_fma_f32 v[66:67], v[66:67], v[22:23], v[166:167] op_sel_hi:[1,0,1]
    v_pk_fma_f32 v[68:69], v[68:69], v[22:23], v[168:169] op_sel_hi:[1,0,1]
    v_pk_fma_f32 v[70:71], v[70:71], v[22:23], v[170:171] op_sel_hi:[1,0,1]
    v_exp_f32 v180, v64
    v_exp_f32 v181, v65
    v_exp_f32 v182, v66
    v_exp_f32 v183, v67
    v_exp_f32 v184, v68
    v_exp_f32 v185, v69
    v_exp_f32 v186, v70
    v_exp_f32 v187, v71
    v_pk_add_f32 v[188:189], v[180:181], 2.0 op_sel_hi:[1,0]
    v_pk_add_f32 v[190:191], v[182:183], 2.0 op_sel_hi:[1,0]
    v_pk_add_f32 v[192:193], v[184:185], 2.0 op_sel_hi:[1,0]
    v_pk_add_f32 v[194:195], v[186:187], 2.0 op_sel_hi:[1,0]
    v_pk_fma_f32 v[188:189], v[188:189], v[180:181], 2.0 op_sel_hi:[1,1,0]
    v_pk_fma_f32 v[190:191], v[190:191], v[182:183], 2.0 op_sel_hi:[1,1,0]
    v_pk_fma_f32 v[192:193], v[192:193], v[184:185], 2.0 op_sel_hi:[1,1,0]
    v_pk_fma_f32 v[194:195], v[194:195], v[186:187], 2.0 op_sel_hi:[1,1,0]
    v_rcp_f32 v188, v188
    v_rcp_f32 v189, v189
    v_rcp_f32 v190, v190
    v_rcp_f32 v191, v191
    v_rcp_f32 v192, v192
    v_rcp_f32 v193, v193
    v_rcp_f32 v194, v194
    v_rcp_f32 v195, v195
    v_pk_fma_f32 v[188:189], v[188:189], s[30:31], v[196:197]
    v_pk_fma_f32 v[190:191], v[190:191], s[30:31], v[196:197]
    v_pk_fma_f32 v[192:193], v[192:193], s[30:31], v[196:197]
    v_pk_fma_f32 v[194:195], v[194:195], s[30:31], v[196:197]
    v_pk_mul_f32 v[64:65], v[64:65], v[188:189]
    v_pk_mul_f32 v[66:67], v[66:67], v[190:191]
    v_pk_mul_f32 v[68:69], v[68:69], v[192:193]
    v_pk_mul_f32 v[70:71], v[70:71], v[194:195]
    v_cvt_pk_bf16_f32 v112, v64, v65
    v_cvt_pk_bf16_f32 v113, v66, v67
    v_cvt_pk_bf16_f32 v114, v68, v69
    v_cvt_pk_bf16_f32 v115, v70, v71
    v_pk_fma_f32 v[72:73], v[72:73], v[22:23], v[172:173] op_sel_hi:[1,0,1]
    v_pk_fma_f32 v[74:75], v[74:75], v[22:23], v[174:175] op_sel_hi:[1,0,1]
    v_pk_fma_f32 v[76:77], v[76:77], v[22:23], v[176:177] op_sel_hi:[1,0,1]
    v_pk_fma_f32 v[78:79], v[78:79], v[22:23], v[178:179] op_sel_hi:[1,0,1]
    v_exp_f32 v180, v72
    v_exp_f32 v181, v73
    v_exp_f32 v182, v74
    v_exp_f32 v183, v75
    v_exp_f32 v184, v76
    v_exp_f32 v185, v77
    v_exp_f32 v186, v78
    v_exp_f32 v187, v79
    v_pk_add_f32 v[188:189], v[180:181], 2.0 op_sel_hi:[1,0]
    v_pk_add_f32 v[190:191], v[182:183], 2.0 op_sel_hi:[1,0]
    v_pk_add_f32 v[192:193], v[184:185], 2.0 op_sel_hi:[1,0]
    v_pk_add_f32 v[194:195], v[186:187], 2.0 op_sel_hi:[1,0]
    v_pk_fma_f32 v[188:189], v[188:189], v[180:181], 2.0 op_sel_hi:[1,1,0]
    v_pk_fma_f32 v[190:191], v[190:191], v[182:183], 2.0 op_sel_hi:[1,1,0]
    v_pk_fma_f32 v[192:193], v[192:193], v[184:185], 2.0 op_sel_hi:[1,1,0]
    v_pk_fma_f32 v[194:195], v[194:195], v[186:187], 2.0 op_sel_hi:[1,1,0]
    v_rcp_f32 v188, v188
    v_rcp_f32 v189, v189
    v_rcp_f32 v190, v190
    v_rcp_f32 v191, v191
    v_rcp_f32 v192, v192
    v_rcp_f32 v193, v193
    v_rcp_f32 v194, v194
    v_rcp_f32 v195, v195
    v_pk_fma_f32 v[188:189], v[188:189], s[30:31], v[196:197]
    v_pk_fma_f32 v[190:191], v[190:191], s[30:31], v[196:197]
    v_pk_fma_f32 v[192:193], v[192:193], s[30:31], v[196:197]
    v_pk_fma_f32 v[194:195], v[194:195], s[30:31], v[196:197]
    v_pk_mul_f32 v[72:73], v[72:73], v[188:189]
    v_pk_mul_f32 v[74:75], v[74:75], v[190:191]
    v_pk_mul_f32 v[76:77], v[76:77], v[192:193]
    v_pk_mul_f32 v[78:79], v[78:79], v[194:195]
    v_cvt_pk_bf16_f32 v116, v72, v73
    v_cvt_pk_bf16_f32 v117, v74, v75
    v_cvt_pk_bf16_f32 v118, v76, v77
    v_cvt_pk_bf16_f32 v119, v78, v79
    buffer_store_dwordx4 v[112:115], v4, s[20:23], s52 offen sc1
    buffer_store_dwordx4 v[116:119], v4, s[20:23], s52 offen offset:1024 sc1
L_npm:
    s_cmp_eq_u32 s24, 0
    s_cbranch_scc0 L_b2w
    s_waitcnt vmcnt(1)
L_b2w:
    s_waitcnt lgkmcnt(0)
    s_barrier
    s_cmp_eq_u32 s24, 0
    s_cbranch_scc1 L_m0
    ds_read_b128 v[8:11], v243
    ds_read_b128 v[12:15], v243 offset:1024
    s_cmp_eq_u32 s24, 1
    s_cbranch_scc0 L_m2
    s_setprio 0
    v_pk_fma_f32 v[80:81], v[80:81], v[20:21], v[164:165] op_sel_hi:[1,0,1]
    v_pk_fma_f32 v[82:83], v[82:83], v[20:21], v[166:167] op_sel_hi:[1,0,1]
    v_pk_fma_f32 v[84:85], v[84:85], v[20:21], v[168:169] op_sel_hi:[1,0,1]
    v_pk_fma_f32 v[86:87], v[86:87], v[20:21], v[170:171] op_sel_hi:[1,0,1]
    v_exp_f32 v180, v80
    v_exp_f32 v181, v81
    v_exp_f32 v182, v82
    v_exp_f32 v183, v83
    v_exp_f32 v184, v84
    v_exp_f32 v185, v85
    v_exp_f32 v186, v86
    v_exp_f32 v187, v87
    v_pk_add_f32 v[188:189], v[180:181], 2.0 op_sel_hi:[1,0]
    v_pk_add_f32 v[190:191], v[182:183], 2.0 op_sel_hi:[1,0]
    v_pk_add_f32 v[192:193], v[184:185], 2.0 op_sel_hi:[1,0]
    v_pk_add_f32 v[194:195], v[186:187], 2.0 op_sel_hi:[1,0]
    v_pk_fma_f32 v[188:189], v[188:189], v[180:181], 2.0 op_sel_hi:[1,1,0]
    v_pk_fma_f32 v[190:191], v[190:191], v[182:183], 2.0 op_sel_hi:[1,1,0]
    v_pk_fma_f32 v[192:193], v[192:193], v[184:185], 2.0 op_sel_hi:[1,1,0]
    v_pk_fma_f32 v[194:195], v[194:195], v[186:187], 2.0 op_sel_hi:[1,1,0]
    v_rcp_f32 v188, v188
    v_rcp_f32 v189, v189
    v_rcp_f32 v190, v190
    v_rcp_f32 v191, v191
    v_rcp_f32 v192, v192
    v_rcp_f32 v193, v193
    v_rcp_f32 v194, v194
    v_rcp_f32 v195, v195
    v_pk_fma_f32 v[188:189], v[188:189], s[30:31], v[196:197]
    v_pk_fma_f32 v[190:191], v[190:191], s[30:31], v[196:197]
    v_pk_fma_f32 v[192:193], v[192:193], s[30:31], v[196:197]
    v_pk_fma_f32 v[194:195], v[194:195], s[30:31], v[196:197]
    v_pk_mul_f32 v[80:81], v[80:81], v[188:189]
    v_pk_mul_f32 v[82:83], v[82:83], v[190:191]
    v_pk_mul_f32 v[84:85], v[84:85], v[192:193]
    v_pk_mul_f32 v[86:87], v[86:87], v[194:195]
    v_cvt_pk_bf16_f32 v120, v80, v81
    v_cvt_pk_bf16_f32 v121, v82, v83
    v_cvt_pk_bf16_f32 v122, v84, v85
    v_cvt_pk_bf16_f32 v123, v86, v87
    v_pk_fma_f32 v[88:89], v[88:89], v[20:21], v[172:173] op_sel_hi:[1,0,1]
    v_pk_fma_f32 v[90:91], v[90:91], v[20:21], v[174:175] op_sel_hi:[1,0,1]
    v_pk_fma_f32 v[92:93], v[92:93], v[20:21], v[176:177] op_sel_hi:[1,0,1]
    v_pk_fma_f32 v[94:95], v[94:95], v[20:21], v[178:179] op_sel_hi:[1,0,1]
    v_exp_f32 v180, v88
    v_exp_f32 v181, v89
    v_exp_f32 v182, v90
    v_exp_f32 v183, v91
    v_exp_f32 v184, v92
    v_exp_f32 v185, v93
    v_exp_f32 v186, v94
    v_exp_f32 v187, v95
    v_pk_add_f32 v[188:189], v[180:181], 2.0 op_sel_hi:[1,0]
    v_pk_add_f32 v[190:191], v[182:183], 2.0 op_sel_hi:[1,0]
    v_pk_add_f32 v[192:193], v[184:185], 2.0 op_sel_hi:[1,0]
    v_pk_add_f32 v[194:195], v[186:187], 2.0 op_sel_hi:[1,0]
    v_pk_fma_f32 v[188:189], v[188:189], v[180:181], 2.0 op_sel_hi:[1,1,0]
    v_pk_fma_f32 v[190:191], v[190:191], v[182:183], 2.0 op_sel_hi:[1,1,0]
    v_pk_fma_f32 v[192:193], v[192:193], v[184:185], 2.0 op_sel_hi:[1,1,0]
    v_pk_fma_f32 v[194:195], v[194:195], v[186:187], 2.0 op_sel_hi:[1,1,0]
    v_rcp_f32 v188, v188
    v_rcp_f32 v189, v189
    v_rcp_f32 v190, v190
    v_rcp_f32 v191, v191
    v_rcp_f32 v192, v192
    v_rcp_f32 v193, v193
    v_rcp_f32 v194, v194
    v_rcp_f32 v195, v195
    v_pk_fma_f32 v[188:189], v[188:189], s[30:31], v[196:197]
    v_pk_fma_f32 v[190:191], v[190:191], s[30:31], v[196:197]
    v_pk_fma_f32 v[192:193], v[192:193], s[30:31], v[196:197]
    v_pk_fma_f32 v[194:195], v[194:195], s[30:31], v[196:197]
    v_pk_mul_f32 v[88:89], v[88:89], v[188:189]
    v_pk_mul_f32 v[90:91], v[90:91], v[190:191]
    v_pk_mul_f32 v[92:93], v[92:93], v[192:193]
    v_pk_mul_f32 v[94:95], v[94:95], v[194:195]
    v_cvt_pk_bf16_f32 v124, v88, v89
    v_cvt_pk_bf16_f32 v125, v90, v91
    v_cvt_pk_bf16_f32 v126, v92, v93
    v_cvt_pk_bf16_f32 v127, v94, v95
    buffer_store_dwordx4 v[120:123], v4, s[20:23], s53 offen sc1
    buffer_store_dwordx4 v[124:127], v4, s[20:23], s53 offen offset:1024 sc1
    s_mov_b32 s89, 3
    s_branch L_md
L_m0:
    s_bitcmp1_b32 s3, 0
    s_cselect_b32 s52, s53, s52
    s_cselect_b32 s89, 2, 1
    v_pk_fma_f32 v[80:81], v[80:81], v[22:23], v[164:165] op_sel_hi:[1,0,1]
    v_pk_fma_f32 v[82:83], v[82:83], v[22:23], v[166:167] op_sel_hi:[1,0,1]
    v_pk_fma_f32 v[84:85], v[84:85], v[22:23], v[168:169] op_sel_hi:[1,0,1]
    v_pk_fma_f32 v[86:87], v[86:87], v[22:23], v[170:171] op_sel_hi:[1,0,1]
    v_exp_f32 v180, v80
    v_exp_f32 v181, v81
    v_exp_f32 v182, v82
    v_exp_f32 v183, v83
    v_exp_f32 v184, v84
    v_exp_f32 v185, v85
    v_exp_f32 v186, v86
    v_exp_f32 v187, v87
    s_add_u32 m0, s80, s81
    s_add_u32 s88, s82, s81
    s_add_u32 s81, s81, 4096
    buffer_load_dwordx4 v4, s[20:23], s88 offen sc1 lds
    s_cmp_eq_u32 s81, 102400
    s_cselect_b32 s81, 0, s81
    s_add_u32 m0, s80, s81
    s_add_u32 s88, s82, s81
    s_add_u32 s81, s81, 4096
    buffer_load_dwordx4 v4, s[20:23], s88 offen sc1 lds
    s_cmp_eq_u32 s81, 102400
    s_cselect_b32 s81, 0, s81
    v_pk_add_f32 v[188:189], v[180:181], 2.0 op_sel_hi:[1,0]
    v_pk_add_f32 v[190:191], v[182:183], 2.0 op_sel_hi:[1,0]
    v_pk_add_f32 v[192:193], v[184:185], 2.0 op_sel_hi:[1,0]
    v_pk_add_f32 v[194:195], v[186:187], 2.0 op_sel_hi:[1,0]
    v_pk_fma_f32 v[188:189], v[188:189], v[180:181], 2.0 op_sel_hi:[1,1,0]
    v_pk_fma_f32 v[190:191], v[190:191], v[182:183], 2.0 op_sel_hi:[1,1,0]
    v_pk_fma_f32 v[192:193], v[192:193], v[184:185], 2.0 op_sel_hi:[1,1,0]
    v_pk_fma_f32 v[194:195], v[194:195], v[186:187], 2.0 op_sel_hi:[1,1,0]
    v_rcp_f32 v188, v188
    v_rcp_f32 v189, v189
    v_rcp_f32 v190, v190
    v_rcp_f32 v191, v191
    v_rcp_f32 v192, v192
    v_rcp_f32 v193, v193
    v_rcp_f32 v194, v194
    v_rcp_f32 v195, v195
    s_add_u32 m0, s80, s81
    s_add_u32 s88, s82, s81
    s_add_u32 s81, s81, 4096
    buffer_load_dwordx4 v4, s[20:23], s88 offen sc1 lds
    s_cmp_eq_u32 s81, 102400
    s_cselect_b32 s81, 0, s81
    s_add_u32 m0, s80, s81
    s_add_u32 s88, s82, s81
    s_add_u32 s81, s81, 4096
    buffer_load_dwordx4 v4, s[20:23], s88 offen sc1 lds
    s_cmp_eq_u32 s81, 102400
    s_cselect_b32 s81, 0, s81
    v_pk_fma_f32 v[188:189], v[188:189], s[30:31], v[196:197]
    v_pk_fma_f32 v[190:191], v[190:191], s[30:31], v[196:197]
    v_pk_fma_f32 v[192:193], v[192:193], s[30:31], v[196:197]
    v_pk_fma_f32 v[194:195], v[194:195], s[30:31], v[196:197]
    v_pk_mul_f32 v[80:81], v[80:81], v[188:189]
    v_pk_mul_f32 v[82:83], v[82:83], v[190:191]
    v_pk_mul_f32 v[84:85], v[84:85], v[192:193]
    v_pk_mul_f32 v[86:87], v[86:87], v[194:195]
    v_cvt_pk_bf16_f32 v112, v80, v81
    v_cvt_pk_bf16_f32 v113, v82, v83
    v_cvt_pk_bf16_f32 v114, v84, v85
    v_cvt_pk_bf16_f32 v115, v86, v87
    v_pk_fma_f32 v[88:89], v[88:89], v[22:23], v[172:173] op_sel_hi:[1,0,1]
    v_pk_fma_f32 v[90:91], v[90:91], v[22:23], v[174:175] op_sel_hi:[1,0,1]
    v_pk_fma_f32 v[92:93], v[92:93], v[22:23], v[176:177] op_sel_hi:[1,0,1]
    v_pk_fma_f32 v[94:95], v[94:95], v[22:23], v[178:179] op_sel_hi:[1,0,1]
    v_exp_f32 v180, v88
    v_exp_f32 v181, v89
    v_exp_f32 v182, v90
    v_exp_f32 v183, v91
    v_exp_f32 v184, v92
    v_exp_f32 v185, v93
    v_exp_f32 v186, v94
    v_exp_f32 v187, v95
    s_add_u32 m0, s80, s81
    s_add_u32 s88, s82, s81
    s_add_u32 s81, s81, 4096
    buffer_load_dwordx4 v4, s[20:23], s88 offen sc1 lds
    s_cmp_eq_u32 s81, 102400
    s_cselect_b32 s81, 0, s81
    s_add_u32 m0, s80, s81
    s_add_u32 s88, s82, s81
    s_add_u32 s81, s81, 4096
    buffer_load_dwordx4 v4, s[20:23], s88 offen sc1 lds
    s_cmp_eq_u32 s81, 102400
    s_cselect_b32 s81, 0, s81
    v_pk_add_f32 v[188:189], v[180:181], 2.0 op_sel_hi:[1,0]
    v_pk_add_f32 v[190:191], v[182:183], 2.0 op_sel_hi:[1,0]
    v_pk_add_f32 v[192:193], v[184:185], 2.0 op_sel_hi:[1,0]
    v_pk_add_f32 v[194:195], v[186:187], 2.0 op_sel_hi:[1,0]
    v_pk_fma_f32 v[188:189], v[188:189], v[180:181], 2.0 op_sel_hi:[1,1,0]
    v_pk_fma_f32 v[190:191], v[190:191], v[182:183], 2.0 op_sel_hi:[1,1,0]
    v_pk_fma_f32 v[192:193], v[192:193], v[184:185], 2.0 op_sel_hi:[1,1,0]
    v_pk_fma_f32 v[194:195], v[194:195], v[186:187], 2.0 op_sel_hi:[1,1,0]
    v_rcp_f32 v188, v188
    v_rcp_f32 v189, v189
    v_rcp_f32 v190, v190
    v_rcp_f32 v191, v191
    v_rcp_f32 v192, v192
    v_rcp_f32 v193, v193
    v_rcp_f32 v194, v194
    v_rcp_f32 v195, v195
    s_add_u32 m0, s80, s81
    s_add_u32 s88, s82, s81
    s_add_u32 s81, s81, 4096
    buffer_load_dwordx4 v4, s[20:23], s88 offen sc1 lds
    s_cmp_eq_u32 s81, 102400
    s_cselect_b32 s81, 0, s81
    s_add_u32 m0, s80, s81
    s_add_u32 s88, s82, s81
    s_add_u32 s81, s81, 4096
    buffer_load_dwordx4 v4, s[20:23], s88 offen sc1 lds
    s_cmp_eq_u32 s81, 102400
    s_cselect_b32 s81, 0, s81
    v_pk_fma_f32 v[188:189], v[188:189], s[30:31], v[196:197]
    v_pk_fma_f32 v[190:191], v[190:191], s[30:31], v[196:197]
    v_pk_fma_f32 v[192:193], v[192:193], s[30:31], v[196:197]
    v_pk_fma_f32 v[194:195], v[194:195], s[30:31], v[196:197]
    v_pk_mul_f32 v[88:89], v[88:89], v[188:189]
    v_pk_mul_f32 v[90:91], v[90:91], v[190:191]
    v_pk_mul_f32 v[92:93], v[92:93], v[192:193]
    v_pk_mul_f32 v[94:95], v[94:95], v[194:195]
    v_cvt_pk_bf16_f32 v116, v88, v89
    v_cvt_pk_bf16_f32 v117, v90, v91
    v_cvt_pk_bf16_f32 v118, v92, v93
    v_cvt_pk_bf16_f32 v119, v94, v95
    buffer_store_dwordx4 v[112:115], v4, s[20:23], s52 offen sc1
    buffer_store_dwordx4 v[116:119], v4, s[20:23], s52 offen offset:1024 sc1
    s_branch L_md
L_m2:
    s_mov_b32 s89, 0
L_md:
    ds_read_b32 v6, v244
    ds_read_b128 v[16:19], v236
    ds_read_b128 v[20:23], v237
    ds_read_b128 v[24:27], v237 offset:544
    s_waitcnt lgkmcnt(2)
    v_mfma_f32_32x32x16_bf16 v[48:63], v[16:19], v[8:11], 0
    v_cmp_eq_u32 vcc, 1, v6
    s_cbranch_vccz L_slow
    s_nop 6
    s_setprio 0
    s_setprio 0
    v_mfma_f32_32x32x16_bf16 v[64:79], v[16:19], v[12:15], 0
    ds_read_b128 v[16:19], v236 offset:4224
    v_exp_f32 v48, v48
    v_exp_f32 v49, v49
    v_exp_f32 v50, v50
    v_exp_f32 v51, v51
    v_cvt_pk_bf16_f32 v36, v48, v49
    ds_read_b128 v[28:31], v237 offset:4224
    ds_read_b128 v[32:35], v237 offset:4768
    v_exp_f32 v52, v52
    v_exp_f32 v53, v53
    v_cvt_pk_bf16_f32 v37, v50, v51
    v_exp_f32 v54, v54
    v_exp_f32 v55, v55
    v_cvt_pk_bf16_f32 v38, v52, v53
    v_exp_f32 v56, v56
    v_exp_f32 v57, v57
    v_cvt_pk_bf16_f32 v39, v54, v55
    v_exp_f32 v58, v58
    v_exp_f32 v59, v59
    s_waitcnt lgkmcnt(3)
    v_mfma_f32_32x32x16_bf16 v[80:95], v[20:23], v[36:39], 0
    s_cmp_eq_u32 s24, 0
    s_cbranch_scc0 L_kv_2
    s_add_u32 m0, s80, s81
    s_add_u32 s88, s82, s81
    s_add_u32 s81, s81, 4096
    buffer_load_dwordx4 v4, s[20:23], s88 offen sc1 lds
    s_cmp_eq_u32 s81, 102400
    s_cselect_b32 s81, 0, s81
    s_add_u32 m0, s80, s81
    s_add_u32 s88, s82, s81
    s_add_u32 s81, s81, 4096
    buffer_load_dwordx4 v4, s[20:23], s88 offen sc1 lds
    s_cmp_eq_u32 s81, 102400
    s_cselect_b32 s81, 0, s81
L_kv_2:
    v_cvt_pk_bf16_f32 v40, v56, v57
    v_exp_f32 v60, v60
    v_exp_f32 v61, v61
    v_cvt_pk_bf16_f32 v41, v58, v59
    v_exp_f32 v62, v62
    v_exp_f32 v63, v63
    v_cvt_pk_bf16_f32 v42, v60, v61
    v_cvt_pk_bf16_f32 v43, v62, v63
    s_waitcnt lgkmcnt(0)
    v_mfma_f32_32x32x16_bf16 v[48:63], v[16:19], v[8:11], 0
    v_exp_f32 v64, v64
    v_exp_f32 v65, v65
    v_exp_f32 v66, v66
    v_exp_f32 v67, v67
    v_cvt_pk_bf16_f32 v36, v64, v65
    v_mfma_f32_32x32x16_bf16 v[80:95], v[24:27], v[40:43], v[80:95]
    v_exp_f32 v68, v68
    v_exp_f32 v69, v69
    v_cvt_pk_bf16_f32 v37, v66, v67
    v_exp_f32 v70, v70
    v_exp_f32 v71, v71
    v_cvt_pk_bf16_f32 v38, v68, v69
    v_exp_f32 v72, v72
    v_exp_f32 v73, v73
    v_cvt_pk_bf16_f32 v39, v70, v71
    v_exp_f32 v74, v74
    v_exp_f32 v75, v75
    v_mfma_f32_32x32x16_bf16 v[96:111], v[20:23], v[36:39], 0
    s_cmp_eq_u32 s24, 0
    s_cbranch_scc0 L_kv_3
    s_add_u32 m0, s80, s81
    s_add_u32 s88, s82, s81
    s_add_u32 s81, s81, 4096
    buffer_load_dwordx4 v4, s[20:23], s88 offen sc1 lds
    s_cmp_eq_u32 s81, 102400
    s_cselect_b32 s81, 0, s81
    s_add_u32 m0, s80, s81
    s_add_u32 s88, s82, s81
    s_add_u32 s81, s81, 4096
    buffer_load_dwordx4 v4, s[20:23], s88 offen sc1 lds
    s_cmp_eq_u32 s81, 102400
    s_cselect_b32 s81, 0, s81
L_kv_3:
    v_cvt_pk_bf16_f32 v40, v72, v73
    v_exp_f32 v76, v76
    v_exp_f32 v77, v77
    v_cvt_pk_bf16_f32 v41, v74, v75
    v_exp_f32 v78, v78
    v_exp_f32 v79, v79
    v_cvt_pk_bf16_f32 v42, v76, v77
    v_cvt_pk_bf16_f32 v43, v78, v79
    s_cmp_eq_u32 s87, 0
    s_cbranch_scc1 L_sp_5
    s_setprio 1
L_sp_5:
    v_mfma_f32_32x32x16_bf16 v[64:79], v[16:19], v[12:15], 0
    ds_read_b128 v[16:19], v236 offset:8448
    v_exp_f32 v48, v48
    v_exp_f32 v49, v49
    v_exp_f32 v50, v50
    v_exp_f32 v51, v51
    v_cvt_pk_bf16_f32 v36, v48, v49
    v_mfma_f32_32x32x16_bf16 v[96:111], v[24:27], v[40:43], v[96:111]
    ds_read_b128 v[20:23], v237 offset:8448
    ds_read_b128 v[24:27], v237 offset:8992
    v_exp_f32 v52, v52
    v_exp_f32 v53, v53
    v_cvt_pk_bf16_f32 v37, v50, v51
    v_exp_f32 v54, v54
    v_exp_f32 v55, v55
    v_cvt_pk_bf16_f32 v38, v52, v53
    v_exp_f32 v56, v56
    v_exp_f32 v57, v57
    v_cvt_pk_bf16_f32 v39, v54, v55
    v_exp_f32 v58, v58
    v_exp_f32 v59, v59
    v_mfma_f32_32x32x16_bf16 v[80:95], v[28:31], v[36:39], v[80:95]
    s_cmp_eq_u32 s24, 0
    s_cbranch_scc0 L_kv_4
    s_add_u32 m0, s80, s81
    s_add_u32 s88, s82, s81
    s_add_u32 s81, s81, 4096
    buffer_load_dwordx4 v4, s[20:23], s88 offen sc1 lds
    s_cmp_eq_u32 s81, 102400
    s_cselect_b32 s81, 0, s81
    s_add_u32 m0, s80, s81
    s_add_u32 s88, s82, s81
    s_add_u32 s81, s81, 4096
    buffer_load_dwordx4 v4, s[20:23], s88 offen sc1 lds
    s_cmp_eq_u32 s81, 102400
    s_cselect_b32 s81, 0, s81
L_kv_4:
    v_cvt_pk_bf16_f32 v40, v56, v57
    v_exp_f32 v60, v60
    v_exp_f32 v61, v61
    v_cvt_pk_bf16_f32 v41, v58, v59
    v_exp_f32 v62, v62
    v_exp_f32 v63, v63
    v_cvt_pk_bf16_f32 v42, v60, v61
    v_cvt_pk_bf16_f32 v43, v62, v63
    s_waitcnt lgkmcnt(0)
    v_mfma_f32_32x32x16_bf16 v[48:63], v[16:19], v[8:11], 0
    v_exp_f32 v64, v64
    v_exp_f32 v65, v65
    v_exp_f32 v66, v66
    v_exp_f32 v67, v67
    v_cvt_pk_bf16_f32 v36, v64, v65
    v_mfma_f32_32x32x16_bf16 v[80:95], v[32:35], v[40:43], v[80:95]
    v_exp_f32 v68, v68
    v_exp_f32 v69, v69
    v_cvt_pk_bf16_f32 v37, v66, v67
    v_exp_f32 v70, v70
    v_exp_f32 v71, v71
    v_cvt_pk_bf16_f32 v38, v68, v69
    v_exp_f32 v72, v72
    v_exp_f32 v73, v73
    v_cvt_pk_bf16_f32 v39, v70, v71
    v_exp_f32 v74, v74
    v_exp_f32 v75, v75
    v_mfma_f32_32x32x16_bf16 v[96:111], v[28:31], v[36:39], v[96:111]
    s_cmp_eq_u32 s24, 0
    s_cbranch_scc0 L_kv_6
    s_add_u32 m0, s80, s81
    s_add_u32 s88, s82, s81
    s_add_u32 s81, s81, 4096
    buffer_load_dwordx4 v4, s[20:23], s88 offen sc1 lds
    s_cmp_eq_u32 s81, 102400
    s_cselect_b32 s81, 0, s81
    s_add_u32 m0, s80, s81
    s_add_u32 s88, s82, s81
    s_add_u32 s81, s81, 4096
    buffer_load_dwordx4 v4, s[20:23], s88 offen sc1 lds
    s_cmp_eq_u32 s81, 102400
    s_cselect_b32 s81, 0, s81
L_kv_6:
    v_cvt_pk_bf16_f32 v40, v72, v73
    v_exp_f32 v76, v76
    v_exp_f32 v77, v77
    v_cvt_pk_bf16_f32 v41, v74, v75
    v_exp_f32 v78, v78
    v_exp_f32 v79, v79
    v_cvt_pk_bf16_f32 v42, v76, v77
    v_cvt_pk_bf16_f32 v43, v78, v79
    s_setprio 0
    v_mfma_f32_32x32x16_bf16 v[64:79], v[16:19], v[12:15], 0
    ds_read_b128 v[16:19], v236 offset:12672
    v_exp_f32 v48, v48
    v_exp_f32 v49, v49
    v_exp_f32 v50, v50
    v_exp_f32 v51, v51
    v_cvt_pk_bf16_f32 v36, v48, v49
    v_mfma_f32_32x32x16_bf16 v[96:111], v[32:35], v[40:43], v[96:111]
    ds_read_b128 v[28:31], v237 offset:12672
    ds_read_b128 v[32:35], v237 offset:13216
    v_exp_f32 v52, v52
    v_exp_f32 v53, v53
    v_cvt_pk_bf16_f32 v37, v50, v51
    v_exp_f32 v54, v54
    v_exp_f32 v55, v55
    v_cvt_pk_bf16_f32 v38, v52, v53
    v_exp_f32 v56, v56
    v_exp_f32 v57, v57
    v_cvt_pk_bf16_f32 v39, v54, v55
    v_exp_f32 v58, v58
    v_exp_f32 v59, v59
    v_mfma_f32_32x32x16_bf16 v[80:95], v[20:23], v[36:39], v[80:95]
    s_cmp_eq_u32 s24, 0
    s_cbranch_scc0 L_kv_7
    s_add_u32 m0, s80, s81
    s_add_u32 s88, s82, s81
    s_add_u32 s81, s81, 4096
    buffer_load_dwordx4 v4, s[20:23], s88 offen sc1 lds
    s_cmp_eq_u32 s81, 102400
    s_cselect_b32 s81, 0, s81
    s_add_u32 m0, s80, s81
    s_add_u32 s88, s82, s81
    s_add_u32 s81, s81, 4096
    buffer_load_dwordx4 v4, s[20:23], s88 offen sc1 lds
    s_cmp_eq_u32 s81, 102400
    s_cselect_b32 s81, 0, s81
L_kv_7:
    v_cvt_pk_bf16_f32 v40, v56, v57
    v_exp_f32 v60, v60
    v_exp_f32 v61, v61
    v_cvt_pk_bf16_f32 v41, v58, v59
    v_exp_f32 v62, v62
    v_exp_f32 v63, v63
    v_cvt_pk_bf16_f32 v42, v60, v61
    v_cvt_pk_bf16_f32 v43, v62, v63
    s_cmp_eq_u32 s24, 0
    s_cbranch_scc1 L_hf_8a
    s_cmp_eq_u32 s89, 0
    s_cbranch_scc1 L_nohfg5
    s_getreg_b32 s6, hwreg(HW_REG_IB_STS)
    s_lshr_b32 s7, s6, 26
    s_and_b32 s6, s6, 15
    s_and_b32 s7, s7, 0x30
    s_or_b32 s6, s6, s7
    s_cmp_gt_u32 s6, 0
    s_cbranch_scc1 L_nohfg5
    v_mov_b32 v5, s56
    v_lshlrev_b32 v6, 8, v1
    s_mov_b32 exec_lo, s89
    s_mov_b32 exec_hi, 0
    s_waitcnt vmcnt(0)
    buffer_store_dword v5, v6, s[20:23], s100 offen sc1
    s_mov_b64 exec, -1
    s_mov_b32 s89, 0
L_nohfg5:
    s_branch L_hf_8b
L_hf_8a:
    s_cmp_eq_u32 s89, 0
    s_cbranch_scc1 L_nohff5
    s_getreg_b32 s6, hwreg(HW_REG_IB_STS)
    s_lshr_b32 s7, s6, 26
    s_and_b32 s6, s6, 15
    s_and_b32 s7, s7, 0x30
    s_or_b32 s6, s6, s7
    s_cmp_gt_u32 s6, 10
    s_cbranch_scc1 L_nohff5
    v_mov_b32 v5, s56
    v_lshlrev_b32 v6, 8, v1
    s_mov_b32 exec_lo, s89
    s_mov_b32 exec_hi, 0
    s_waitcnt vmcnt(10)
    buffer_store_dword v5, v6, s[20:23], s100 offen sc1
    s_mov_b64 exec, -1
    s_mov_b32 s89, 0
L_nohff5:
L_hf_8b:
    s_waitcnt lgkmcnt(0)
    v_mfma_f32_32x32x16_bf16 v[48:63], v[16:19], v[8:11], 0
    v_exp_f32 v64, v64
    v_exp_f32 v65, v65
    v_exp_f32 v66, v66
    v_exp_f32 v67, v67
    v_cvt_pk_bf16_f32 v36, v64, v65
    v_mfma_f32_32x32x16_bf16 v[80:95], v[24:27], v[40:43], v[80:95]
    v_exp_f32 v68, v68
    v_exp_f32 v69, v69
    v_cvt_pk_bf16_f32 v37, v66, v67
    v_exp_f32 v70, v70
    v_exp_f32 v71, v71
    v_cvt_pk_bf16_f32 v38, v68, v69
    v_exp_f32 v72, v72
    v_exp_f32 v73, v73
    v_cvt_pk_bf16_f32 v39, v70, v71
    v_exp_f32 v74, v74
    v_exp_f32 v75, v75
    v_mfma_f32_32x32x16_bf16 v[96:111], v[20:23], v[36:39], v[96:111]
    s_cmp_eq_u32 s24, 0
    s_cbranch_scc0 L_kv_9
    s_add_u32 m0, s80, s81
    s_add_u32 s88, s82, s81
    s_add_u32 s81, s81, 4096
    buffer_load_dwordx4 v4, s[20:23], s88 offen sc1 lds
    s_cmp_eq_u32 s81, 102400
    s_cselect_b32 s81, 0, s81
    s_add_u32 m0, s80, s81
    s_add_u32 s88, s82, s81
    s_add_u32 s81, s81, 4096
    buffer_load_dwordx4 v4, s[20:23], s88 offen sc1 lds
    s_cmp_eq_u32 s81, 102400
    s_cselect_b32 s81, 0, s81
L_kv_9:
    v_cvt_pk_bf16_f32 v40, v72, v73
    v_exp_f32 v76, v76
    v_exp_f32 v77, v77
    v_cvt_pk_bf16_f32 v41, v74, v75
    v_exp_f32 v78, v78
    v_exp_f32 v79, v79
    v_cvt_pk_bf16_f32 v42, v76, v77
    v_cvt_pk_bf16_f32 v43, v78, v79
    s_cmp_eq_u32 s24, 0
    s_cbranch_scc1 L_hf_10a
    s_cmp_eq_u32 s89, 0
    s_cbranch_scc1 L_nohfg6
    s_getreg_b32 s6, hwreg(HW_REG_IB_STS)
    s_lshr_b32 s7, s6, 26
    s_and_b32 s6, s6, 15
    s_and_b32 s7, s7, 0x30
    s_or_b32 s6, s6, s7
    s_cmp_gt_u32 s6, 0
    s_cbranch_scc1 L_nohfg6
    v_mov_b32 v5, s56
    v_lshlrev_b32 v6, 8, v1
    s_mov_b32 exec_lo, s89
    s_mov_b32 exec_hi, 0
    s_waitcnt vmcnt(0)
    buffer_store_dword v5, v6, s[20:23], s100 offen sc1
    s_mov_b64 exec, -1
    s_mov_b32 s89, 0
L_nohfg6:
    s_branch L_hf_10b
L_hf_10a:
    s_cmp_eq_u32 s89, 0
    s_cbranch_scc1 L_nohff6
    s_getreg_b32 s6, hwreg(HW_REG_IB_STS)
    s_lshr_b32 s7, s6, 26
    s_and_b32 s6, s6, 15
    s_and_b32 s7, s7, 0x30
    s_or_b32 s6, s6, s7
    s_cmp_gt_u32 s6, 12
    s_cbranch_scc1 L_nohff6
    v_mov_b32 v5, s56
    v_lshlrev_b32 v6, 8, v1
    s_mov_b32 exec_lo, s89
    s_mov_b32 exec_hi, 0
    s_waitcnt vmcnt(12)
    buffer_store_dword v5, v6, s[20:23], s100 offen sc1
    s_mov_b64 exec, -1
    s_mov_b32 s89, 0
L_nohff6:
L_hf_10b:
    s_cmp_eq_u32 s87, 0
    s_cbranch_scc1 L_sp_12
    s_setprio 1
L_sp_12:
    v_mfma_f32_32x32x16_bf16 v[64:79], v[16:19], v[12:15], 0
    ds_read_b128 v[16:19], v236 offset:16896
    v_exp_f32 v48, v48
    v_exp_f32 v49, v49
    v_exp_f32 v50, v50
    v_exp_f32 v51, v51
    v_cvt_pk_bf16_f32 v36, v48, v49
    v_mfma_f32_32x32x16_bf16 v[96:111], v[24:27], v[40:43], v[96:111]
    ds_read_b128 v[20:23], v237 offset:16896
    ds_read_b128 v[24:27], v237 offset:17440
    v_exp_f32 v52, v52
    v_exp_f32 v53, v53
    v_cvt_pk_bf16_f32 v37, v50, v51
    v_exp_f32 v54, v54
    v_exp_f32 v55, v55
    v_cvt_pk_bf16_f32 v38, v52, v53
    v_exp_f32 v56, v56
    v_exp_f32 v57, v57
    v_cvt_pk_bf16_f32 v39, v54, v55
    v_exp_f32 v58, v58
    v_exp_f32 v59, v59
    v_mfma_f32_32x32x16_bf16 v[80:95], v[28:31], v[36:39], v[80:95]
    s_cmp_eq_u32 s24, 0
    s_cbranch_scc0 L_kv_11
    s_add_u32 m0, s80, s81
    s_add_u32 s88, s82, s81
    s_add_u32 s81, s81, 4096
    buffer_load_dwordx4 v4, s[20:23], s88 offen sc1 lds
    s_cmp_eq_u32 s81, 102400
    s_cselect_b32 s81, 0, s81
    s_add_u32 m0, s80, s81
    s_add_u32 s88, s82, s81
    s_add_u32 s81, s81, 4096
    buffer_load_dwordx4 v4, s[20:23], s88 offen sc1 lds
    s_cmp_eq_u32 s81, 102400
    s_cselect_b32 s81, 0, s81
L_kv_11:
    v_cvt_pk_bf16_f32 v40, v56, v57
    v_exp_f32 v60, v60
    v_exp_f32 v61, v61
    v_cvt_pk_bf16_f32 v41, v58, v59
    v_exp_f32 v62, v62
    v_exp_f32 v63, v63
    v_cvt_pk_bf16_f32 v42, v60, v61
    v_cvt_pk_bf16_f32 v43, v62, v63
    s_cmp_eq_u32 s24, 0
    s_cbranch_scc1 L_hf_13a
    s_cmp_eq_u32 s89, 0
    s_cbranch_scc1 L_nohfg7
    s_getreg_b32 s6, hwreg(HW_REG_IB_STS)
    s_lshr_b32 s7, s6, 26
    s_and_b32 s6, s6, 15
    s_and_b32 s7, s7, 0x30
    s_or_b32 s6, s6, s7
    s_cmp_gt_u32 s6, 0
    s_cbranch_scc1 L_nohfg7
    v_mov_b32 v5, s56
    v_lshlrev_b32 v6, 8, v1
    s_mov_b32 exec_lo, s89
    s_mov_b32 exec_hi, 0
    s_waitcnt vmcnt(0)
    buffer_store_dword v5, v6, s[20:23], s100 offen sc1
    s_mov_b64 exec, -1
    s_mov_b32 s89, 0
L_nohfg7:
    s_branch L_hf_13b
L_hf_13a:
    s_cmp_eq_u32 s89, 0
    s_cbranch_scc1 L_nohff7
    s_getreg_b32 s6, hwreg(HW_REG_IB_STS)
    s_lshr_b32 s7, s6, 26
    s_and_b32 s6, s6, 15
    s_and_b32 s7, s7, 0x30
    s_or_b32 s6, s6, s7
    s_cmp_gt_u32 s6, 14
    s_cbranch_scc1 L_nohff7
    v_mov_b32 v5, s56
    v_lshlrev_b32 v6, 8, v1
    s_mov_b32 exec_lo, s89
    s_mov_b32 exec_hi, 0
    s_waitcnt vmcnt(14)
    buffer_store_dword v5, v6, s[20:23], s100 offen sc1
    s_mov_b64 exec, -1
    s_mov_b32 s89, 0
L_nohff7:
L_hf_13b:
    s_waitcnt lgkmcnt(0)
    v_mfma_f32_32x32x16_bf16 v[48:63], v[16:19], v[8:11], 0
    v_exp_f32 v64, v64
    v_exp_f32 v65, v65
    v_exp_f32 v66, v66
    v_exp_f32 v67, v67
    v_cvt_pk_bf16_f32 v36, v64, v65
    v_mfma_f32_32x32x16_bf16 v[80:95], v[32:35], v[40:43], v[80:95]
    v_exp_f32 v68, v68
    v_exp_f32 v69, v69
    v_cvt_pk_bf16_f32 v37, v66, v67
    v_exp_f32 v70, v70
    v_exp_f32 v71, v71
    v_cvt_pk_bf16_f32 v38, v68, v69
    v_exp_f32 v72, v72
    v_exp_f32 v73, v73
    v_cvt_pk_bf16_f32 v39, v70, v71
    v_exp_f32 v74, v74
    v_exp_f32 v75, v75
    v_mfma_f32_32x32x16_bf16 v[96:111], v[28:31], v[36:39], v[96:111]
    s_cmp_eq_u32 s24, 0
    s_cbranch_scc0 L_kv_14
    s_add_u32 m0, s80, s81
    s_add_u32 s88, s82, s81
    s_add_u32 s81, s81, 4096
    buffer_load_dwordx4 v4, s[20:23], s88 offen sc1 lds
    s_cmp_eq_u32 s81, 102400
    s_cselect_b32 s81, 0, s81
    s_add_u32 m0, s80, s81
    s_add_u32 s88, s82, s81
    s_add_u32 s81, s81, 4096
    buffer_load_dwordx4 v4, s[20:23], s88 offen sc1 lds
    s_cmp_eq_u32 s81, 102400
    s_cselect_b32 s81, 0, s81
L_kv_14:
    v_cvt_pk_bf16_f32 v40, v72, v73
    v_exp_f32 v76, v76
    v_exp_f32 v77, v77
    v_cvt_pk_bf16_f32 v41, v74, v75
    v_exp_f32 v78, v78
    v_exp_f32 v79, v79
    v_cvt_pk_bf16_f32 v42, v76, v77
    v_cvt_pk_bf16_f32 v43, v78, v79
    s_cmp_eq_u32 s24, 0
    s_cbranch_scc1 L_hf_15a
    s_cmp_eq_u32 s89, 0
    s_cbranch_scc1 L_nohfg8
    v_mov_b32 v5, s56
    v_lshlrev_b32 v6, 8, v1
    s_mov_b32 exec_lo, s89
    s_mov_b32 exec_hi, 0
    s_waitcnt vmcnt(0)
    buffer_store_dword v5, v6, s[20:23], s100 offen sc1
    s_mov_b64 exec, -1
    s_mov_b32 s89, 0
L_nohfg8:
    s_branch L_hf_15b
L_hf_15a:
    s_cmp_eq_u32 s89, 0
    s_cbranch_scc1 L_nohff8
    v_mov_b32 v5, s56
    v_lshlrev_b32 v6, 8, v1
    s_mov_b32 exec_lo, s89
    s_mov_b32 exec_hi, 0
    s_waitcnt vmcnt(16)
    buffer_store_dword v5, v6, s[20:23], s100 offen sc1
    s_mov_b64 exec, -1
    s_mov_b32 s89, 0
L_nohff8:
L_hf_15b:
    s_setprio 0
    v_mfma_f32_32x32x16_bf16 v[64:79], v[16:19], v[12:15], 0
    ds_read_b128 v[16:19], v236 offset:21120
    v_exp_f32 v48, v48
    v_exp_f32 v49, v49
    v_exp_f32 v50, v50
    v_exp_f32 v51, v51
    v_cvt_pk_bf16_f32 v36, v48, v49
    v_mfma_f32_32x32x16_bf16 v[96:111], v[32:35], v[40:43], v[96:111]
    ds_read_b128 v[28:31], v237 offset:21120
    ds_read_b128 v[32:35], v237 offset:21664
    v_exp_f32 v52, v52
    v_exp_f32 v53, v53
    v_cvt_pk_bf16_f32 v37, v50, v51
    v_exp_f32 v54, v54
    v_exp_f32 v55, v55
    v_cvt_pk_bf16_f32 v38, v52, v53
    v_exp_f32 v56, v56
    v_exp_f32 v57, v57
    v_cvt_pk_bf16_f32 v39, v54, v55
    v_exp_f32 v58, v58
    v_exp_f32 v59, v59
    v_mfma_f32_32x32x16_bf16 v[80:95], v[20:23], v[36:39], v[80:95]
    s_cmp_eq_u32 s24, 0
    s_cbranch_scc0 L_kv_16
    s_add_u32 m0, s80, s81
    s_add_u32 s88, s82, s81
    s_add_u32 s81, s81, 4096
    buffer_load_dwordx4 v4, s[20:23], s88 offen sc1 lds
    s_cmp_eq_u32 s81, 102400
    s_cselect_b32 s81, 0, s81
L_kv_16:
    v_cvt_pk_bf16_f32 v40, v56, v57
    v_exp_f32 v60, v60
    v_exp_f32 v61, v61
    v_cvt_pk_bf16_f32 v41, v58, v59
    v_exp_f32 v62, v62
    v_exp_f32 v63, v63
    v_cvt_pk_bf16_f32 v42, v60, v61
    v_cvt_pk_bf16_f32 v43, v62, v63
    s_waitcnt lgkmcnt(0)
    v_mfma_f32_32x32x16_bf16 v[48:63], v[16:19], v[8:11], 0
    s_mov_b32 m0, s61
    v_exp_f32 v64, v64
    v_exp_f32 v65, v65
    buffer_load_dwordx4 v241, s[76:79], s74 offen lds
    v_exp_f32 v66, v66
    v_exp_f32 v67, v67
    v_cvt_pk_bf16_f32 v36, v64, v65
    v_mfma_f32_32x32x16_bf16 v[80:95], v[24:27], v[40:43], v[80:95]
    v_exp_f32 v68, v68
    v_exp_f32 v69, v69
    v_cvt_pk_bf16_f32 v37, v66, v67
    v_exp_f32 v70, v70
    v_exp_f32 v71, v71
    buffer_load_dwordx4 v228, s[76:79], s74 offen offset:1024 lds
    s_add_u32 s74, s74, 16384
    v_cvt_pk_bf16_f32 v38, v68, v69
    v_exp_f32 v72, v72
    v_exp_f32 v73, v73
    v_cvt_pk_bf16_f32 v39, v70, v71
    v_exp_f32 v74, v74
    v_exp_f32 v75, v75
    v_mfma_f32_32x32x16_bf16 v[96:111], v[20:23], v[36:39], v[96:111]
    v_cvt_pk_bf16_f32 v40, v72, v73
    v_exp_f32 v76, v76
    v_exp_f32 v77, v77
    v_cvt_pk_bf16_f32 v41, v74, v75
    v_exp_f32 v78, v78
    v_exp_f32 v79, v79
    v_cvt_pk_bf16_f32 v42, v76, v77
    v_cvt_pk_bf16_f32 v43, v78, v79
    s_cmp_eq_u32 s87, 0
    s_cbranch_scc1 L_sp_17
    s_setprio 1
L_sp_17:
    v_mfma_f32_32x32x16_bf16 v[64:79], v[16:19], v[12:15], 0
    ds_read_b128 v[16:19], v236 offset:25344
    v_exp_f32 v48, v48
    v_exp_f32 v49, v49
    v_exp_f32 v50, v50
    v_exp_f32 v51, v51
    v_cvt_pk_bf16_f32 v36, v48, v49
    v_mfma_f32_32x32x16_bf16 v[96:111], v[24:27], v[40:43], v[96:111]
    ds_read_b128 v[20:23], v237 offset:25344
    ds_read_b128 v[24:27], v237 offset:25888
    v_exp_f32 v52, v52
    v_exp_f32 v53, v53
    v_cvt_pk_bf16_f32 v37, v50, v51
    v_exp_f32 v54, v54
    v_exp_f32 v55, v55
    v_cvt_pk_bf16_f32 v38, v52, v53
    v_exp_f32 v56, v56
    v_exp_f32 v57, v57
    v_cvt_pk_bf16_f32 v39, v54, v55
    v_exp_f32 v58, v58
    v_exp_f32 v59, v59
    v_mfma_f32_32x32x16_bf16 v[80:95], v[28:31], v[36:39], v[80:95]
    v_cvt_pk_bf16_f32 v40, v56, v57
    v_exp_f32 v60, v60
    v_exp_f32 v61, v61
    v_cvt_pk_bf16_f32 v41, v58, v59
    v_exp_f32 v62, v62
    v_exp_f32 v63, v63
    v_cvt_pk_bf16_f32 v42, v60, v61
    v_cvt_pk_bf16_f32 v43, v62, v63
    buffer_load_dwordx4 v[160:163], v242, s[8:11], 0 offen
    s_lshl_b32 s6, s69, 8
    s_add_u32 s6, s6, 532480
    v_min_u32 v5, 42, v1
    v_lshlrev_b32 v5, 2, v5
    buffer_load_dword v6, v5, s[20:23], s6 offen sc1
    s_waitcnt lgkmcnt(0)
    v_mfma_f32_32x32x16_bf16 v[48:63], v[16:19], v[8:11], 0
    v_exp_f32 v64, v64
    v_exp_f32 v65, v65
    v_exp_f32 v66, v66
    v_exp_f32 v67, v67
    v_cvt_pk_bf16_f32 v36, v64, v65
    v_mfma_f32_32x32x16_bf16 v[80:95], v[32:35], v[40:43], v[80:95]
    v_exp_f32 v68, v68
    v_exp_f32 v69, v69
    v_cvt_pk_bf16_f32 v37, v66, v67
    v_exp_f32 v70, v70
    v_exp_f32 v71, v71
    v_cvt_pk_bf16_f32 v38, v68, v69
    v_exp_f32 v72, v72
    v_exp_f32 v73, v73
    v_cvt_pk_bf16_f32 v39, v70, v71
    v_exp_f32 v74, v74
    v_exp_f32 v75, v75
    v_mfma_f32_32x32x16_bf16 v[96:111], v[28:31], v[36:39], v[96:111]
    v_cvt_pk_bf16_f32 v40, v72, v73
    v_exp_f32 v76, v76
    v_exp_f32 v77, v77
    v_cvt_pk_bf16_f32 v41, v74, v75
    v_exp_f32 v78, v78
    v_exp_f32 v79, v79
    v_cvt_pk_bf16_f32 v42, v76, v77
    v_cvt_pk_bf16_f32 v43, v78, v79
    s_waitcnt vmcnt(4)
    s_barrier
    s_setprio 0
    v_mfma_f32_32x32x16_bf16 v[64:79], v[16:19], v[12:15], 0
    ds_read_b128 v[16:19], v236 offset:29568
    s_mov_b32 m0, s62
    v_exp_f32 v48, v48
    v_exp_f32 v49, v49
    buffer_load_dwordx4 v241, s[76:79], s74 offen lds
    v_exp_f32 v50, v50
    v_exp_f32 v51, v51
    v_cvt_pk_bf16_f32 v36, v48, v49
    v_mfma_f32_32x32x16_bf16 v[96:111], v[32:35], v[40:43], v[96:111]
    ds_read_b128 v[28:31], v237 offset:29568
    ds_read_b128 v[32:35], v237 offset:30112
    buffer_load_dwordx4 v228, s[76:79], s74 offen offset:1024 lds
    s_add_u32 s74, s74, 16384
    s_cmp_eq_u32 s74, s44
    s_cselect_b32 s88, 294912, 0
    s_sub_u32 s74, s74, s88
    v_exp_f32 v52, v52
    v_exp_f32 v53, v53
    v_cvt_pk_bf16_f32 v37, v50, v51
    v_exp_f32 v54, v54
    v_exp_f32 v55, v55
    v_cvt_pk_bf16_f32 v38, v52, v53
    v_exp_f32 v56, v56
    v_exp_f32 v57, v57
    v_cvt_pk_bf16_f32 v39, v54, v55
    v_exp_f32 v58, v58
    v_exp_f32 v59, v59
    v_mfma_f32_32x32x16_bf16 v[80:95], v[20:23], v[36:39], v[80:95]
    v_cvt_pk_bf16_f32 v40, v56, v57
    v_exp_f32 v60, v60
    v_exp_f32 v61, v61
    v_cvt_pk_bf16_f32 v41, v58, v59
    v_exp_f32 v62, v62
    v_exp_f32 v63, v63
    v_cvt_pk_bf16_f32 v42, v60, v61
    v_cvt_pk_bf16_f32 v43, v62, v63
    s_mov_b32 s7, 200000
    s_waitcnt vmcnt(2)
L_phf:
    v_cmp_ne_u32 vcc, s56, v6
    s_cbranch_vccz L_hokf
    s_sub_u32 s7, s7, 1
    s_cmp_eq_u32 s7, 0
    s_cbranch_scc1 L_hokf
    s_sleep 1
    buffer_load_dword v6, v5, s[20:23], s6 offen sc1
    s_waitcnt vmcnt(0)
    s_branch L_phf
L_hokf:
    s_cmp_eq_u32 s87, 0
    s_cbranch_scc1 L_sp_18
    s_setprio 1
L_sp_18:
    s_waitcnt lgkmcnt(0)
    v_mfma_f32_32x32x16_bf16 v[48:63], v[16:19], v[8:11], 0
    v_exp_f32 v64, v64
    v_exp_f32 v65, v65
    buffer_load_dwordx4 v[152:155], v4, s[64:67], s75 offen offset:0 sc1
    v_exp_f32 v66, v66
    v_exp_f32 v67, v67
    v_cvt_pk_bf16_f32 v36, v64, v65
    v_mfma_f32_32x32x16_bf16 v[80:95], v[24:27], v[40:43], v[80:95]
    buffer_load_dwordx4 v[156:159], v4, s[64:67], s75 offen offset:1024 sc1
    s_add_u32 s75, s75, 2048
    s_cmp_eq_u32 s75, s45
    s_cselect_b32 s88, 18432, 0
    s_sub_u32 s75, s75, s88
    v_exp_f32 v68, v68
    v_exp_f32 v69, v69
    v_cvt_pk_bf16_f32 v37, v66, v67
    v_exp_f32 v70, v70
    v_exp_f32 v71, v71
    v_cvt_pk_bf16_f32 v38, v68, v69
    v_exp_f32 v72, v72
    v_exp_f32 v73, v73
    v_cvt_pk_bf16_f32 v39, v70, v71
    v_exp_f32 v74, v74
    v_exp_f32 v75, v75
    v_mfma_f32_32x32x16_bf16 v[96:111], v[20:23], v[36:39], v[96:111]
    v_cvt_pk_bf16_f32 v40, v72, v73
    v_exp_f32 v76, v76
    v_exp_f32 v77, v77
    v_cvt_pk_bf16_f32 v41, v74, v75
    v_exp_f32 v78, v78
    v_exp_f32 v79, v79
    v_cvt_pk_bf16_f32 v42, v76, v77
    v_cvt_pk_bf16_f32 v43, v78, v79
    v_mfma_f32_32x32x16_bf16 v[64:79], v[16:19], v[12:15], 0
    ds_read_b128 v[16:19], v236 offset:33792
    v_exp_f32 v48, v48
    v_exp_f32 v49, v49
    v_exp_f32 v50, v50
    v_exp_f32 v51, v51
    v_cvt_pk_bf16_f32 v36, v48, v49
    v_mfma_f32_32x32x16_bf16 v[96:111], v[24:27], v[40:43], v[96:111]
    ds_read_b128 v[20:23], v237 offset:33792
    ds_read_b128 v[24:27], v237 offset:34336
    v_exp_f32 v52, v52
    v_exp_f32 v53, v53
    v_cvt_pk_bf16_f32 v37, v50, v51
    v_exp_f32 v54, v54
    v_exp_f32 v55, v55
    v_cvt_pk_bf16_f32 v38, v52, v53
    v_exp_f32 v56, v56
    v_exp_f32 v57, v57
    v_cvt_pk_bf16_f32 v39, v54, v55
    v_exp_f32 v58, v58
    v_exp_f32 v59, v59
    v_mfma_f32_32x32x16_bf16 v[80:95], v[28:31], v[36:39], v[80:95]
    s_waitcnt vmcnt(4)
    ds_read_b64_tr_b16 v[144:145], v239
    ds_read_b64_tr_b16 v[146:147], v239 offset:1024
    ds_read_b64_tr_b16 v[148:149], v239 offset:256
    ds_read_b64_tr_b16 v[150:151], v239 offset:1280
    v_cvt_pk_bf16_f32 v40, v56, v57
    v_exp_f32 v60, v60
    v_exp_f32 v61, v61
    v_cvt_pk_bf16_f32 v41, v58, v59
    v_exp_f32 v62, v62
    v_exp_f32 v63, v63
    v_cvt_pk_bf16_f32 v42, v60, v61
    v_cvt_pk_bf16_f32 v43, v62, v63
    s_waitcnt lgkmcnt(0)
    v_mfma_f32_32x32x16_bf16 v[48:63], v[16:19], v[8:11], 0
    s_mov_b32 m0, s61
    v_exp_f32 v64, v64
    v_exp_f32 v65, v65
    v_exp_f32 v66, v66
    v_exp_f32 v67, v67
    v_cvt_pk_bf16_f32 v36, v64, v65
    v_mfma_f32_32x32x16_bf16 v[80:95], v[32:35], v[40:43], v[80:95]
    buffer_load_dwordx4 v241, s[76:79], s74 offen lds
    v_exp_f32 v68, v68
    v_exp_f32 v69, v69
    v_cvt_pk_bf16_f32 v37, v66, v67
    v_exp_f32 v70, v70
    v_exp_f32 v71, v71
    s_waitcnt vmcnt(2)
    v_mfma_f32_32x32x16_bf16 v[112:127], v[144:147], v[152:155], 0
    v_cvt_pk_bf16_f32 v38, v68, v69
    v_exp_f32 v72, v72
    v_exp_f32 v73, v73
    v_cvt_pk_bf16_f32 v39, v70, v71
    v_exp_f32 v74, v74
    v_exp_f32 v75, v75
    v_mfma_f32_32x32x16_bf16 v[96:111], v[28:31], v[36:39], v[96:111]
    buffer_load_dwordx4 v228, s[76:79], s74 offen offset:1024 lds
    s_add_u32 s74, s74, 16384
    v_cvt_pk_bf16_f32 v40, v72, v73
    v_exp_f32 v76, v76
    v_exp_f32 v77, v77
    v_cvt_pk_bf16_f32 v41, v74, v75
    v_exp_f32 v78, v78
    v_exp_f32 v79, v79
    v_cvt_pk_bf16_f32 v42, v76, v77
    v_cvt_pk_bf16_f32 v43, v78, v79
    s_setprio 0
    v_mfma_f32_32x32x16_bf16 v[64:79], v[16:19], v[12:15], 0
    ds_read_b128 v[16:19], v236 offset:38016
    v_exp_f32 v48, v48
    v_exp_f32 v49, v49
    v_exp_f32 v50, v50
    v_exp_f32 v51, v51
    v_cvt_pk_bf16_f32 v36, v48, v49
    v_mfma_f32_32x32x16_bf16 v[96:111], v[32:35], v[40:43], v[96:111]
    ds_read_b128 v[28:31], v237 offset:38016
    ds_read_b128 v[32:35], v237 offset:38560
    v_exp_f32 v52, v52
    v_exp_f32 v53, v53
    v_cvt_pk_bf16_f32 v37, v50, v51
    v_exp_f32 v54, v54
    v_exp_f32 v55, v55
    v_mfma_f32_32x32x16_bf16 v[128:143], v[148:151], v[152:155], 0
    buffer_load_dwordx4 v[152:155], v4, s[64:67], s75 offen offset:0 sc1
    v_cvt_pk_bf16_f32 v38, v52, v53
    v_exp_f32 v56, v56
    v_exp_f32 v57, v57
    v_cvt_pk_bf16_f32 v39, v54, v55
    v_exp_f32 v58, v58
    v_exp_f32 v59, v59
    v_mfma_f32_32x32x16_bf16 v[80:95], v[20:23], v[36:39], v[80:95]
    s_waitcnt vmcnt(4)
    ds_read_b64_tr_b16 v[144:145], v240
    ds_read_b64_tr_b16 v[146:147], v240 offset:1024
    ds_read_b64_tr_b16 v[148:149], v240 offset:256
    ds_read_b64_tr_b16 v[150:151], v240 offset:1280
    v_cvt_pk_bf16_f32 v40, v56, v57
    v_exp_f32 v60, v60
    v_exp_f32 v61, v61
    v_cvt_pk_bf16_f32 v41, v58, v59
    v_exp_f32 v62, v62
    v_exp_f32 v63, v63
    v_cvt_pk_bf16_f32 v42, v60, v61
    v_cvt_pk_bf16_f32 v43, v62, v63
    s_cmp_eq_u32 s87, 0
    s_cbranch_scc1 L_sp_19
    s_setprio 1
L_sp_19:
    s_waitcnt lgkmcnt(0)
    v_mfma_f32_32x32x16_bf16 v[48:63], v[16:19], v[8:11], 0
    s_mov_b32 m0, s62
    v_exp_f32 v64, v64
    v_exp_f32 v65, v65
    v_exp_f32 v66, v66
    v_exp_f32 v67, v67
    v_cvt_pk_bf16_f32 v36, v64, v65
    v_mfma_f32_32x32x16_bf16 v[80:95], v[24:27], v[40:43], v[80:95]
    buffer_load_dwordx4 v241, s[76:79], s74 offen lds
    v_exp_f32 v68, v68
    v_exp_f32 v69, v69
    v_cvt_pk_bf16_f32 v37, v66, v67
    v_exp_f32 v70, v70
    v_exp_f32 v71, v71
    s_waitcnt vmcnt(4)
    v_mfma_f32_32x32x16_bf16 v[112:127], v[144:147], v[156:159], v[112:127]
    v_cvt_pk_bf16_f32 v38, v68, v69
    v_exp_f32 v72, v72
    v_exp_f32 v73, v73
    v_cvt_pk_bf16_f32 v39, v70, v71
    v_exp_f32 v74, v74
    v_exp_f32 v75, v75
    v_mfma_f32_32x32x16_bf16 v[96:111], v[20:23], v[36:39], v[96:111]
    buffer_load_dwordx4 v228, s[76:79], s74 offen offset:1024 lds
    s_add_u32 s74, s74, 16384
    s_cmp_eq_u32 s74, s44
    s_cselect_b32 s88, 294912, 0
    s_sub_u32 s74, s74, s88
    v_cvt_pk_bf16_f32 v40, v72, v73
    v_exp_f32 v76, v76
    v_exp_f32 v77, v77
    v_cvt_pk_bf16_f32 v41, v74, v75
    v_exp_f32 v78, v78
    v_exp_f32 v79, v79
    v_cvt_pk_bf16_f32 v42, v76, v77
    v_cvt_pk_bf16_f32 v43, v78, v79
    v_mfma_f32_32x32x16_bf16 v[64:79], v[16:19], v[12:15], 0
    ds_read_b128 v[16:19], v236 offset:42240
    v_exp_f32 v48, v48
    v_exp_f32 v49, v49
    v_exp_f32 v50, v50
    v_exp_f32 v51, v51
    v_cvt_pk_bf16_f32 v36, v48, v49
    v_mfma_f32_32x32x16_bf16 v[96:111], v[24:27], v[40:43], v[96:111]
    ds_read_b128 v[20:23], v237 offset:42240
    ds_read_b128 v[24:27], v237 offset:42784
    v_exp_f32 v52, v52
    v_exp_f32 v53, v53
    v_cvt_pk_bf16_f32 v37, v50, v51
    v_exp_f32 v54, v54
    v_exp_f32 v55, v55
    v_mfma_f32_32x32x16_bf16 v[128:143], v[148:151], v[156:159], v[128:143]
    buffer_load_dwordx4 v[156:159], v4, s[64:67], s75 offen offset:1024 sc1
    s_add_u32 s75, s75, 2048
    s_cmp_eq_u32 s75, s45
    s_cselect_b32 s88, 18432, 0
    s_sub_u32 s75, s75, s88
    v_cvt_pk_bf16_f32 v38, v52, v53
    v_exp_f32 v56, v56
    v_exp_f32 v57, v57
    v_cvt_pk_bf16_f32 v39, v54, v55
    v_exp_f32 v58, v58
    v_exp_f32 v59, v59
    v_mfma_f32_32x32x16_bf16 v[80:95], v[28:31], v[36:39], v[80:95]
    s_waitcnt vmcnt(4)
    ds_read_b64_tr_b16 v[144:145], v239
    ds_read_b64_tr_b16 v[146:147], v239 offset:1024
    ds_read_b64_tr_b16 v[148:149], v239 offset:256
    ds_read_b64_tr_b16 v[150:151], v239 offset:1280
    v_cvt_pk_bf16_f32 v40, v56, v57
    v_exp_f32 v60, v60
    v_exp_f32 v61, v61
    v_cvt_pk_bf16_f32 v41, v58, v59
    v_exp_f32 v62, v62
    v_exp_f32 v63, v63
    v_cvt_pk_bf16_f32 v42, v60, v61
    v_cvt_pk_bf16_f32 v43, v62, v63
    s_waitcnt lgkmcnt(0)
    v_mfma_f32_32x32x16_bf16 v[48:63], v[16:19], v[8:11], 0
    s_mov_b32 m0, s61
    v_exp_f32 v64, v64
    v_exp_f32 v65, v65
    v_exp_f32 v66, v66
    v_exp_f32 v67, v67
    v_cvt_pk_bf16_f32 v36, v64, v65
    v_mfma_f32_32x32x16_bf16 v[80:95], v[32:35], v[40:43], v[80:95]
    buffer_load_dwordx4 v241, s[76:79], s74 offen lds
    v_exp_f32 v68, v68
    v_exp_f32 v69, v69
    v_cvt_pk_bf16_f32 v37, v66, v67
    v_exp_f32 v70, v70
    v_exp_f32 v71, v71
    s_waitcnt vmcnt(4)
    v_mfma_f32_32x32x16_bf16 v[112:127], v[144:147], v[152:155], v[112:127]
    v_cvt_pk_bf16_f32 v38, v68, v69
    v_exp_f32 v72, v72
    v_exp_f32 v73, v73
    v_cvt_pk_bf16_f32 v39, v70, v71
    v_exp_f32 v74, v74
    v_exp_f32 v75, v75
    v_mfma_f32_32x32x16_bf16 v[96:111], v[28:31], v[36:39], v[96:111]
    buffer_load_dwordx4 v228, s[76:79], s74 offen offset:1024 lds
    s_add_u32 s74, s74, 16384
    v_cvt_pk_bf16_f32 v40, v72, v73
    v_exp_f32 v76, v76
    v_exp_f32 v77, v77
    v_cvt_pk_bf16_f32 v41, v74, v75
    v_exp_f32 v78, v78
    v_exp_f32 v79, v79
    v_cvt_pk_bf16_f32 v42, v76, v77
    v_cvt_pk_bf16_f32 v43, v78, v79
    s_setprio 0
    v_mfma_f32_32x32x16_bf16 v[64:79], v[16:19], v[12:15], 0
    ds_read_b128 v[16:19], v236 offset:46464
    v_exp_f32 v48, v48
    v_exp_f32 v49, v49
    v_exp_f32 v50, v50
    v_exp_f32 v51, v51
    v_cvt_pk_bf16_f32 v36, v48, v49
    v_mfma_f32_32x32x16_bf16 v[96:111], v[32:35], v[40:43], v[96:111]
    ds_read_b128 v[28:31], v237 offset:46464
    ds_read_b128 v[32:35], v237 offset:47008
    v_exp_f32 v52, v52
    v_exp_f32 v53, v53
    v_cvt_pk_bf16_f32 v37, v50, v51
    v_exp_f32 v54, v54
    v_exp_f32 v55, v55
    v_mfma_f32_32x32x16_bf16 v[128:143], v[148:151], v[152:155], v[128:143]
    buffer_load_dwordx4 v[152:155], v4, s[64:67], s75 offen offset:0 sc1
    v_cvt_pk_bf16_f32 v38, v52, v53
    v_exp_f32 v56, v56
    v_exp_f32 v57, v57
    v_cvt_pk_bf16_f32 v39, v54, v55
    v_exp_f32 v58, v58
    v_exp_f32 v59, v59
    v_mfma_f32_32x32x16_bf16 v[80:95], v[20:23], v[36:39], v[80:95]
    s_waitcnt vmcnt(4)
    ds_read_b64_tr_b16 v[144:145], v240
    ds_read_b64_tr_b16 v[146:147], v240 offset:1024
    ds_read_b64_tr_b16 v[148:149], v240 offset:256
    ds_read_b64_tr_b16 v[150:151], v240 offset:1280
    v_cvt_pk_bf16_f32 v40, v56, v57
    v_exp_f32 v60, v60
    v_exp_f32 v61, v61
    v_cvt_pk_bf16_f32 v41, v58, v59
    v_exp_f32 v62, v62
    v_exp_f32 v63, v63
    v_cvt_pk_bf16_f32 v42, v60, v61
    v_cvt_pk_bf16_f32 v43, v62, v63
    s_cmp_eq_u32 s87, 0
    s_cbranch_scc1 L_sp_20
    s_setprio 1
L_sp_20:
    s_waitcnt lgkmcnt(0)
    v_mfma_f32_32x32x16_bf16 v[48:63], v[16:19], v[8:11], 0
    s_mov_b32 m0, s62
    v_exp_f32 v64, v64
    v_exp_f32 v65, v65
    v_exp_f32 v66, v66
    v_exp_f32 v67, v67
    v_cvt_pk_bf16_f32 v36, v64, v65
    v_mfma_f32_32x32x16_bf16 v[80:95], v[24:27], v[40:43], v[80:95]
    buffer_load_dwordx4 v241, s[76:79], s74 offen lds
    v_exp_f32 v68, v68
    v_exp_f32 v69, v69
    v_cvt_pk_bf16_f32 v37, v66, v67
    v_exp_f32 v70, v70
    v_exp_f32 v71, v71
    s_waitcnt vmcnt(4)
    v_mfma_f32_32x32x16_bf16 v[112:127], v[144:147], v[156:159], v[112:127]
    v_cvt_pk_bf16_f32 v38, v68, v69
    v_exp_f32 v72, v72
    v_exp_f32 v73, v73
    v_cvt_pk_bf16_f32 v39, v70, v71
    v_exp_f32 v74, v74
    v_exp_f32 v75, v75
    v_mfma_f32_32x32x16_bf16 v[96:111], v[20:23], v[36:39], v[96:111]
    buffer_load_dwordx4 v228, s[76:79], s74 offen offset:1024 lds
    s_add_u32 s74, s74, 16384
    s_cmp_eq_u32 s74, s44
    s_cselect_b32 s88, 294912, 0
    s_sub_u32 s74, s74, s88
    v_cvt_pk_bf16_f32 v40, v72, v73
    v_exp_f32 v76, v76
    v_exp_f32 v77, v77
    v_cvt_pk_bf16_f32 v41, v74, v75
    v_exp_f32 v78, v78
    v_exp_f32 v79, v79
    v_cvt_pk_bf16_f32 v42, v76, v77
    v_cvt_pk_bf16_f32 v43, v78, v79
    v_mfma_f32_32x32x16_bf16 v[64:79], v[16:19], v[12:15], 0
    ds_read_b128 v[16:19], v236 offset:50688
    v_exp_f32 v48, v48
    v_exp_f32 v49, v49
    v_exp_f32 v50, v50
    v_exp_f32 v51, v51
    v_cvt_pk_bf16_f32 v36, v48, v49
    v_mfma_f32_32x32x16_bf16 v[96:111], v[24:27], v[40:43], v[96:111]
    ds_read_b128 v[20:23], v237 offset:50688
    ds_read_b128 v[24:27], v237 offset:51232
    v_exp_f32 v52, v52
    v_exp_f32 v53, v53
    v_cvt_pk_bf16_f32 v37, v50, v51
    v_exp_f32 v54, v54
    v_exp_f32 v55, v55
    v_mfma_f32_32x32x16_bf16 v[128:143], v[148:151], v[156:159], v[128:143]
    buffer_load_dwordx4 v[156:159], v4, s[64:67], s75 offen offset:1024 sc1
    s_add_u32 s75, s75, 2048
    s_cmp_eq_u32 s75, s45
    s_cselect_b32 s88, 18432, 0
    s_sub_u32 s75, s75, s88
    v_cvt_pk_bf16_f32 v38, v52, v53
    v_exp_f32 v56, v56
    v_exp_f32 v57, v57
    v_cvt_pk_bf16_f32 v39, v54, v55
    v_exp_f32 v58, v58
    v_exp_f32 v59, v59
    v_mfma_f32_32x32x16_bf16 v[80:95], v[28:31], v[36:39], v[80:95]
    s_waitcnt vmcnt(4)
    ds_read_b64_tr_b16 v[144:145], v239
    ds_read_b64_tr_b16 v[146:147], v239 offset:1024
    ds_read_b64_tr_b16 v[148:149], v239 offset:256
    ds_read_b64_tr_b16 v[150:151], v239 offset:1280
    v_cvt_pk_bf16_f32 v40, v56, v57
    v_exp_f32 v60, v60
    v_exp_f32 v61, v61
    v_cvt_pk_bf16_f32 v41, v58, v59
    v_exp_f32 v62, v62
    v_exp_f32 v63, v63
    v_cvt_pk_bf16_f32 v42, v60, v61
    v_cvt_pk_bf16_f32 v43, v62, v63
    s_waitcnt lgkmcnt(0)
    v_mfma_f32_32x32x16_bf16 v[48:63], v[16:19], v[8:11], 0
    s_mov_b32 m0, s61
    v_exp_f32 v64, v64
    v_exp_f32 v65, v65
    v_exp_f32 v66, v66
    v_exp_f32 v67, v67
    v_cvt_pk_bf16_f32 v36, v64, v65
    v_mfma_f32_32x32x16_bf16 v[80:95], v[32:35], v[40:43], v[80:95]
    buffer_load_dwordx4 v241, s[76:79], s74 offen lds
    v_exp_f32 v68, v68
    v_exp_f32 v69, v69
    v_cvt_pk_bf16_f32 v37, v66, v67
    v_exp_f32 v70, v70
    v_exp_f32 v71, v71
    s_waitcnt vmcnt(4)
    v_mfma_f32_32x32x16_bf16 v[112:127], v[144:147], v[152:155], v[112:127]
    v_cvt_pk_bf16_f32 v38, v68, v69
    v_exp_f32 v72, v72
    v_exp_f32 v73, v73
    v_cvt_pk_bf16_f32 v39, v70, v71
    v_exp_f32 v74, v74
    v_exp_f32 v75, v75
    v_mfma_f32_32x32x16_bf16 v[96:111], v[28:31], v[36:39], v[96:111]
    buffer_load_dwordx4 v228, s[76:79], s74 offen offset:1024 lds
    s_add_u32 s74, s74, 16384
    v_cvt_pk_bf16_f32 v40, v72, v73
    v_exp_f32 v76, v76
    v_exp_f32 v77, v77
    v_cvt_pk_bf16_f32 v41, v74, v75
    v_exp_f32 v78, v78
    v_exp_f32 v79, v79
    v_cvt_pk_bf16_f32 v42, v76, v77
    v_cvt_pk_bf16_f32 v43, v78, v79
    s_setprio 0
    v_mfma_f32_32x32x16_bf16 v[64:79], v[16:19], v[12:15], 0
    ds_read_b128 v[16:19], v236 offset:54912
    v_exp_f32 v48, v48
    v_exp_f32 v49, v49
    v_exp_f32 v50, v50
    v_exp_f32 v51, v51
    v_cvt_pk_bf16_f32 v36, v48, v49
    v_mfma_f32_32x32x16_bf16 v[96:111], v[32:35], v[40:43], v[96:111]
    ds_read_b128 v[28:31], v237 offset:54912
    ds_read_b128 v[32:35], v237 offset:55456
    v_exp_f32 v52, v52
    v_exp_f32 v53, v53
    v_cvt_pk_bf16_f32 v37, v50, v51
    v_exp_f32 v54, v54
    v_exp_f32 v55, v55
    v_mfma_f32_32x32x16_bf16 v[128:143], v[148:151], v[152:155], v[128:143]
    buffer_load_dwordx4 v[152:155], v4, s[64:67], s75 offen offset:0 sc1
    v_cvt_pk_bf16_f32 v38, v52, v53
    v_exp_f32 v56, v56
    v_exp_f32 v57, v57
    v_cvt_pk_bf16_f32 v39, v54, v55
    v_exp_f32 v58, v58
    v_exp_f32 v59, v59
    v_mfma_f32_32x32x16_bf16 v[80:95], v[20:23], v[36:39], v[80:95]
    s_waitcnt vmcnt(4)
    ds_read_b64_tr_b16 v[144:145], v240
    ds_read_b64_tr_b16 v[146:147], v240 offset:1024
    ds_read_b64_tr_b16 v[148:149], v240 offset:256
    ds_read_b64_tr_b16 v[150:151], v240 offset:1280
    v_cvt_pk_bf16_f32 v40, v56, v57
    v_exp_f32 v60, v60
    v_exp_f32 v61, v61
    v_cvt_pk_bf16_f32 v41, v58, v59
    v_exp_f32 v62, v62
    v_exp_f32 v63, v63
    v_cvt_pk_bf16_f32 v42, v60, v61
    v_cvt_pk_bf16_f32 v43, v62, v63
    s_cmp_eq_u32 s87, 0
    s_cbranch_scc1 L_sp_21
    s_setprio 1
L_sp_21:
    s_waitcnt lgkmcnt(0)
    v_mfma_f32_32x32x16_bf16 v[48:63], v[16:19], v[8:11], 0
    s_mov_b32 m0, s62
    v_exp_f32 v64, v64
    v_exp_f32 v65, v65
    v_exp_f32 v66, v66
    v_exp_f32 v67, v67
    v_cvt_pk_bf16_f32 v36, v64, v65
    v_mfma_f32_32x32x16_bf16 v[80:95], v[24:27], v[40:43], v[80:95]
    buffer_load_dwordx4 v241, s[76:79], s74 offen lds
    v_exp_f32 v68, v68
    v_exp_f32 v69, v69
    v_cvt_pk_bf16_f32 v37, v66, v67
    v_exp_f32 v70, v70
    v_exp_f32 v71, v71
    s_waitcnt vmcnt(4)
    v_mfma_f32_32x32x16_bf16 v[112:127], v[144:147], v[156:159], v[112:127]
    v_cvt_pk_bf16_f32 v38, v68, v69
    v_exp_f32 v72, v72
    v_exp_f32 v73, v73
    v_cvt_pk_bf16_f32 v39, v70, v71
    v_exp_f32 v74, v74
    v_exp_f32 v75, v75
    v_mfma_f32_32x32x16_bf16 v[96:111], v[20:23], v[36:39], v[96:111]
    buffer_load_dwordx4 v228, s[76:79], s74 offen offset:1024 lds
    s_add_u32 s74, s74, 16384
    s_cmp_eq_u32 s74, s44
    s_cselect_b32 s88, 294912, 0
    s_sub_u32 s74, s74, s88
    v_cvt_pk_bf16_f32 v40, v72, v73
    v_exp_f32 v76, v76
    v_exp_f32 v77, v77
    v_cvt_pk_bf16_f32 v41, v74, v75
    v_exp_f32 v78, v78
    v_exp_f32 v79, v79
    v_cvt_pk_bf16_f32 v42, v76, v77
    v_cvt_pk_bf16_f32 v43, v78, v79
    v_mfma_f32_32x32x16_bf16 v[64:79], v[16:19], v[12:15], 0
    ds_read_b128 v[16:19], v236 offset:59136
    v_exp_f32 v48, v48
    v_exp_f32 v49, v49
    v_exp_f32 v50, v50
    v_exp_f32 v51, v51
    v_cvt_pk_bf16_f32 v36, v48, v49
    v_mfma_f32_32x32x16_bf16 v[96:111], v[24:27], v[40:43], v[96:111]
    ds_read_b128 v[20:23], v237 offset:59136
    ds_read_b128 v[24:27], v237 offset:59680
    v_exp_f32 v52, v52
    v_exp_f32 v53, v53
    v_cvt_pk_bf16_f32 v37, v50, v51
    v_exp_f32 v54, v54
    v_exp_f32 v55, v55
    v_mfma_f32_32x32x16_bf16 v[128:143], v[148:151], v[156:159], v[128:143]
    buffer_load_dwordx4 v[156:159], v4, s[64:67], s75 offen offset:1024 sc1
    s_add_u32 s75, s75, 2048
    s_cmp_eq_u32 s75, s45
    s_cselect_b32 s88, 18432, 0
    s_sub_u32 s75, s75, s88
    v_cvt_pk_bf16_f32 v38, v52, v53
    v_exp_f32 v56, v56
    v_exp_f32 v57, v57
    v_cvt_pk_bf16_f32 v39, v54, v55
    v_exp_f32 v58, v58
    v_exp_f32 v59, v59
    v_mfma_f32_32x32x16_bf16 v[80:95], v[28:31], v[36:39], v[80:95]
    s_waitcnt vmcnt(4)
    ds_read_b64_tr_b16 v[144:145], v239
    ds_read_b64_tr_b16 v[146:147], v239 offset:1024
    ds_read_b64_tr_b16 v[148:149], v239 offset:256
    ds_read_b64_tr_b16 v[150:151], v239 offset:1280
    v_cvt_pk_bf16_f32 v40, v56, v57
    v_exp_f32 v60, v60
    v_exp_f32 v61, v61
    v_cvt_pk_bf16_f32 v41, v58, v59
    v_exp_f32 v62, v62
    v_exp_f32 v63, v63
    v_cvt_pk_bf16_f32 v42, v60, v61
    v_cvt_pk_bf16_f32 v43, v62, v63
    s_waitcnt lgkmcnt(0)
    v_mfma_f32_32x32x16_bf16 v[48:63], v[16:19], v[8:11], 0
    s_mov_b32 m0, s61
    v_exp_f32 v64, v64
    v_exp_f32 v65, v65
    v_exp_f32 v66, v66
    v_exp_f32 v67, v67
    v_cvt_pk_bf16_f32 v36, v64, v65
    v_mfma_f32_32x32x16_bf16 v[80:95], v[32:35], v[40:43], v[80:95]
    buffer_load_dwordx4 v241, s[76:79], s74 offen lds
    v_exp_f32 v68, v68
    v_exp_f32 v69, v69
    v_cvt_pk_bf16_f32 v37, v66, v67
    v_exp_f32 v70, v70
    v_exp_f32 v71, v71
    s_waitcnt vmcnt(4)
    v_mfma_f32_32x32x16_bf16 v[112:127], v[144:147], v[152:155], v[112:127]
    v_cvt_pk_bf16_f32 v38, v68, v69
    v_exp_f32 v72, v72
    v_exp_f32 v73, v73
    v_cvt_pk_bf16_f32 v39, v70, v71
    v_exp_f32 v74, v74
    v_exp_f32 v75, v75
    v_mfma_f32_32x32x16_bf16 v[96:111], v[28:31], v[36:39], v[96:111]
    buffer_load_dwordx4 v228, s[76:79], s74 offen offset:1024 lds
    s_add_u32 s74, s74, 16384
    v_cvt_pk_bf16_f32 v40, v72, v73
    v_exp_f32 v76, v76
    v_exp_f32 v77, v77
    v_cvt_pk_bf16_f32 v41, v74, v75
    v_exp_f32 v78, v78
    v_exp_f32 v79, v79
    v_cvt_pk_bf16_f32 v42, v76, v77
    v_cvt_pk_bf16_f32 v43, v78, v79
    s_setprio 0
    v_mfma_f32_32x32x16_bf16 v[64:79], v[16:19], v[12:15], 0
    ds_read_b128 v[16:19], v236 offset:63360
    v_exp_f32 v48, v48
    v_exp_f32 v49, v49
    v_exp_f32 v50, v50
    v_exp_f32 v51, v51
    v_cvt_pk_bf16_f32 v36, v48, v49
    v_mfma_f32_32x32x16_bf16 v[96:111], v[32:35], v[40:43], v[96:111]
    ds_read_b128 v[28:31], v237 offset:63360
    ds_read_b128 v[32:35], v237 offset:63904
    v_exp_f32 v52, v52
    v_exp_f32 v53, v53
    v_cvt_pk_bf16_f32 v37, v50, v51
    v_exp_f32 v54, v54
    v_exp_f32 v55, v55
    v_mfma_f32_32x32x16_bf16 v[128:143], v[148:151], v[152:155], v[128:143]
    buffer_load_dwordx4 v[152:155], v4, s[64:67], s75 offen offset:0 sc1
    v_cvt_pk_bf16_f32 v38, v52, v53
    v_exp_f32 v56, v56
    v_exp_f32 v57, v57
    v_cvt_pk_bf16_f32 v39, v54, v55
    v_exp_f32 v58, v58
    v_exp_f32 v59, v59
    v_mfma_f32_32x32x16_bf16 v[80:95], v[20:23], v[36:39], v[80:95]
    s_waitcnt vmcnt(4)
    ds_read_b64_tr_b16 v[144:145], v240
    ds_read_b64_tr_b16 v[146:147], v240 offset:1024
    ds_read_b64_tr_b16 v[148:149], v240 offset:256
    ds_read_b64_tr_b16 v[150:151], v240 offset:1280
    v_cvt_pk_bf16_f32 v40, v56, v57
    v_exp_f32 v60, v60
    v_exp_f32 v61, v61
    v_cvt_pk_bf16_f32 v41, v58, v59
    v_exp_f32 v62, v62
    v_exp_f32 v63, v63
    v_cvt_pk_bf16_f32 v42, v60, v61
    v_cvt_pk_bf16_f32 v43, v62, v63
    s_cmp_eq_u32 s87, 0
    s_cbranch_scc1 L_sp_22
    s_setprio 1
L_sp_22:
    s_waitcnt lgkmcnt(0)
    v_mfma_f32_32x32x16_bf16 v[48:63], v[16:19], v[8:11], 0
    s_mov_b32 m0, s62
    v_exp_f32 v64, v64
    v_exp_f32 v65, v65
    v_exp_f32 v66, v66
    v_exp_f32 v67, v67
    v_cvt_pk_bf16_f32 v36, v64, v65
    v_mfma_f32_32x32x16_bf16 v[80:95], v[24:27], v[40:43], v[80:95]
    buffer_load_dwordx4 v241, s[76:79], s74 offen lds
    v_exp_f32 v68, v68
    v_exp_f32 v69, v69
    v_cvt_pk_bf16_f32 v37, v66, v67
    v_exp_f32 v70, v70
    v_exp_f32 v71, v71
    s_waitcnt vmcnt(4)
    v_mfma_f32_32x32x16_bf16 v[112:127], v[144:147], v[156:159], v[112:127]
    v_cvt_pk_bf16_f32 v38, v68, v69
    v_exp_f32 v72, v72
    v_exp_f32 v73, v73
    v_cvt_pk_bf16_f32 v39, v70, v71
    v_exp_f32 v74, v74
    v_exp_f32 v75, v75
    v_mfma_f32_32x32x16_bf16 v[96:111], v[20:23], v[36:39], v[96:111]
    buffer_load_dwordx4 v228, s[76:79], s74 offen offset:1024 lds
    s_add_u32 s74, s74, 16384
    s_cmp_eq_u32 s74, s44
    s_cselect_b32 s88, 294912, 0
    s_sub_u32 s74, s74, s88
    v_cvt_pk_bf16_f32 v40, v72, v73
    v_exp_f32 v76, v76
    v_exp_f32 v77, v77
    v_cvt_pk_bf16_f32 v41, v74, v75
    v_exp_f32 v78, v78
    v_exp_f32 v79, v79
    v_cvt_pk_bf16_f32 v42, v76, v77
    v_cvt_pk_bf16_f32 v43, v78, v79
    v_add_u32 v236, 63360, v236
    v_add_u32 v237, 63360, v237
    v_mfma_f32_32x32x16_bf16 v[64:79], v[16:19], v[12:15], 0
    ds_read_b128 v[16:19], v236 offset:4224
    v_exp_f32 v48, v48
    v_exp_f32 v49, v49
    v_exp_f32 v50, v50
    v_exp_f32 v51, v51
    v_cvt_pk_bf16_f32 v36, v48, v49
    v_mfma_f32_32x32x16_bf16 v[96:111], v[24:27], v[40:43], v[96:111]
    ds_read_b128 v[20:23], v237 offset:4224
    ds_read_b128 v[24:27], v237 offset:4768
    v_exp_f32 v52, v52
    v_exp_f32 v53, v53
    v_cvt_pk_bf16_f32 v37, v50, v51
    v_exp_f32 v54, v54
    v_exp_f32 v55, v55
    v_mfma_f32_32x32x16_bf16 v[128:143], v[148:151], v[156:159], v[128:143]
    buffer_load_dwordx4 v[156:159], v4, s[64:67], s75 offen offset:1024 sc1
    s_add_u32 s75, s75, 2048
    s_cmp_eq_u32 s75, s45
    s_cselect_b32 s88, 18432, 0
    s_sub_u32 s75, s75, s88
    v_cvt_pk_bf16_f32 v38, v52, v53
    v_exp_f32 v56, v56
    v_exp_f32 v57, v57
    v_cvt_pk_bf16_f32 v39, v54, v55
    v_exp_f32 v58, v58
    v_exp_f32 v59, v59
    v_mfma_f32_32x32x16_bf16 v[80:95], v[28:31], v[36:39], v[80:95]
    s_waitcnt vmcnt(4)
    ds_read_b64_tr_b16 v[144:145], v239
    ds_read_b64_tr_b16 v[146:147], v239 offset:1024
    ds_read_b64_tr_b16 v[148:149], v239 offset:256
    ds_read_b64_tr_b16 v[150:151], v239 offset:1280
    v_cvt_pk_bf16_f32 v40, v56, v57
    v_exp_f32 v60, v60
    v_exp_f32 v61, v61
    v_cvt_pk_bf16_f32 v41, v58, v59
    v_exp_f32 v62, v62
    v_exp_f32 v63, v63
    v_cvt_pk_bf16_f32 v42, v60, v61
    v_cvt_pk_bf16_f32 v43, v62, v63
    s_waitcnt lgkmcnt(0)
    v_mfma_f32_32x32x16_bf16 v[48:63], v[16:19], v[8:11], 0
    s_mov_b32 m0, s61
    v_exp_f32 v64, v64
    v_exp_f32 v65, v65
    v_exp_f32 v66, v66
    v_exp_f32 v67, v67
    v_cvt_pk_bf16_f32 v36, v64, v65
    v_mfma_f32_32x32x16_bf16 v[80:95], v[32:35], v[40:43], v[80:95]
    buffer_load_dwordx4 v241, s[76:79], s74 offen lds
    v_exp_f32 v68, v68
    v_exp_f32 v69, v69
    v_cvt_pk_bf16_f32 v37, v66, v67
    v_exp_f32 v70, v70
    v_exp_f32 v71, v71
    s_waitcnt vmcnt(4)
    v_mfma_f32_32x32x16_bf16 v[112:127], v[144:147], v[152:155], v[112:127]
    v_cvt_pk_bf16_f32 v38, v68, v69
    v_exp_f32 v72, v72
    v_exp_f32 v73, v73
    v_cvt_pk_bf16_f32 v39, v70, v71
    v_exp_f32 v74, v74
    v_exp_f32 v75, v75
    v_mfma_f32_32x32x16_bf16 v[96:111], v[28:31], v[36:39], v[96:111]
    buffer_load_dwordx4 v228, s[76:79], s74 offen offset:1024 lds
    s_add_u32 s74, s74, 16384
    v_cvt_pk_bf16_f32 v40, v72, v73
    v_exp_f32 v76, v76
    v_exp_f32 v77, v77
    v_cvt_pk_bf16_f32 v41, v74, v75
    v_exp_f32 v78, v78
    v_exp_f32 v79, v79
    v_cvt_pk_bf16_f32 v42, v76, v77
    v_cvt_pk_bf16_f32 v43, v78, v79
    s_setprio 0
    v_mfma_f32_32x32x16_bf16 v[64:79], v[16:19], v[12:15], 0
    ds_read_b128 v[16:19], v236 offset:8448
    v_exp_f32 v48, v48
    v_exp_f32 v49, v49
    v_exp_f32 v50, v50
    v_exp_f32 v51, v51
    v_cvt_pk_bf16_f32 v36, v48, v49
    v_mfma_f32_32x32x16_bf16 v[96:111], v[32:35], v[40:43], v[96:111]
    ds_read_b128 v[28:31], v237 offset:8448
    ds_read_b128 v[32:35], v237 offset:8992
    v_exp_f32 v52, v52
    v_exp_f32 v53, v53
    v_cvt_pk_bf16_f32 v37, v50, v51
    v_exp_f32 v54, v54
    v_exp_f32 v55, v55
    v_mfma_f32_32x32x16_bf16 v[128:143], v[148:151], v[152:155], v[128:143]
    buffer_load_dwordx4 v[152:155], v4, s[64:67], s75 offen offset:0 sc1
    v_cvt_pk_bf16_f32 v38, v52, v53
    v_exp_f32 v56, v56
    v_exp_f32 v57, v57
    v_cvt_pk_bf16_f32 v39, v54, v55
    v_exp_f32 v58, v58
    v_exp_f32 v59, v59
    v_mfma_f32_32x32x16_bf16 v[80:95], v[20:23], v[36:39], v[80:95]
    s_waitcnt vmcnt(4)
    ds_read_b64_tr_b16 v[144:145], v240
    ds_read_b64_tr_b16 v[146:147], v240 offset:1024
    ds_read_b64_tr_b16 v[148:149], v240 offset:256
    ds_read_b64_tr_b16 v[150:151], v240 offset:1280
    v_cvt_pk_bf16_f32 v40, v56, v57
    v_exp_f32 v60, v60
    v_exp_f32 v61, v61
    v_cvt_pk_bf16_f32 v41, v58, v59
    v_exp_f32 v62, v62
    v_exp_f32 v63, v63
    v_cvt_pk_bf16_f32 v42, v60, v61
    v_cvt_pk_bf16_f32 v43, v62, v63
    s_cmp_eq_u32 s87, 0
    s_cbranch_scc1 L_sp_23
    s_setprio 1
L_sp_23:
    s_waitcnt lgkmcnt(0)
    v_mfma_f32_32x32x16_bf16 v[48:63], v[16:19], v[8:11], 0
    s_mov_b32 m0, s62
    v_exp_f32 v64, v64
    v_exp_f32 v65, v65
    v_exp_f32 v66, v66
    v_exp_f32 v67, v67
    v_cvt_pk_bf16_f32 v36, v64, v65
    v_mfma_f32_32x32x16_bf16 v[80:95], v[24:27], v[40:43], v[80:95]
    buffer_load_dwordx4 v241, s[76:79], s74 offen lds
    v_exp_f32 v68, v68
    v_exp_f32 v69, v69
    v_cvt_pk_bf16_f32 v37, v66, v67
    v_exp_f32 v70, v70
    v_exp_f32 v71, v71
    s_waitcnt vmcnt(4)
    v_mfma_f32_32x32x16_bf16 v[112:127], v[144:147], v[156:159], v[112:127]
    v_cvt_pk_bf16_f32 v38, v68, v69
    v_exp_f32 v72, v72
    v_exp_f32 v73, v73
    v_cvt_pk_bf16_f32 v39, v70, v71
    v_exp_f32 v74, v74
    v_exp_f32 v75, v75
    v_mfma_f32_32x32x16_bf16 v[96:111], v[20:23], v[36:39], v[96:111]
    buffer_load_dwordx4 v228, s[76:79], s74 offen offset:1024 lds
    s_add_u32 s74, s74, 16384
    s_cmp_eq_u32 s74, s44
    s_cselect_b32 s88, 294912, 0
    s_sub_u32 s74, s74, s88
    v_cvt_pk_bf16_f32 v40, v72, v73
    v_exp_f32 v76, v76
    v_exp_f32 v77, v77
    v_cvt_pk_bf16_f32 v41, v74, v75
    v_exp_f32 v78, v78
    v_exp_f32 v79, v79
    v_cvt_pk_bf16_f32 v42, v76, v77
    v_cvt_pk_bf16_f32 v43, v78, v79
    v_mfma_f32_32x32x16_bf16 v[64:79], v[16:19], v[12:15], 0
    ds_read_b128 v[16:19], v236 offset:12672
    v_exp_f32 v48, v48
    v_exp_f32 v49, v49
    v_exp_f32 v50, v50
    v_exp_f32 v51, v51
    v_cvt_pk_bf16_f32 v36, v48, v49
    v_mfma_f32_32x32x16_bf16 v[96:111], v[24:27], v[40:43], v[96:111]
    ds_read_b128 v[20:23], v237 offset:12672
    ds_read_b128 v[24:27], v237 offset:13216
    v_exp_f32 v52, v52
    v_exp_f32 v53, v53
    v_cvt_pk_bf16_f32 v37, v50, v51
    v_exp_f32 v54, v54
    v_exp_f32 v55, v55
    v_mfma_f32_32x32x16_bf16 v[128:143], v[148:151], v[156:159], v[128:143]
    buffer_load_dwordx4 v[156:159], v4, s[64:67], s75 offen offset:1024 sc1
    s_add_u32 s75, s75, 2048
    s_cmp_eq_u32 s75, s45
    s_cselect_b32 s88, 18432, 0
    s_sub_u32 s75, s75, s88
    v_cvt_pk_bf16_f32 v38, v52, v53
    v_exp_f32 v56, v56
    v_exp_f32 v57, v57
    v_cvt_pk_bf16_f32 v39, v54, v55
    v_exp_f32 v58, v58
    v_exp_f32 v59, v59
    v_mfma_f32_32x32x16_bf16 v[80:95], v[28:31], v[36:39], v[80:95]
    s_waitcnt vmcnt(4)
    ds_read_b64_tr_b16 v[144:145], v239
    ds_read_b64_tr_b16 v[146:147], v239 offset:1024
    ds_read_b64_tr_b16 v[148:149], v239 offset:256
    ds_read_b64_tr_b16 v[150:151], v239 offset:1280
    v_cvt_pk_bf16_f32 v40, v56, v57
    v_exp_f32 v60, v60
    v_exp_f32 v61, v61
    v_cvt_pk_bf16_f32 v41, v58, v59
    v_exp_f32 v62, v62
    v_exp_f32 v63, v63
    v_cvt_pk_bf16_f32 v42, v60, v61
    v_cvt_pk_bf16_f32 v43, v62, v63
    s_waitcnt lgkmcnt(0)
    v_mfma_f32_32x32x16_bf16 v[48:63], v[16:19], v[8:11], 0
    s_mov_b32 m0, s61
    v_exp_f32 v64, v64
    v_exp_f32 v65, v65
    v_exp_f32 v66, v66
    v_exp_f32 v67, v67
    v_cvt_pk_bf16_f32 v36, v64, v65
    v_mfma_f32_32x32x16_bf16 v[80:95], v[32:35], v[40:43], v[80:95]
    buffer_load_dwordx4 v241, s[76:79], s74 offen lds
    v_exp_f32 v68, v68
    v_exp_f32 v69, v69
    v_cvt_pk_bf16_f32 v37, v66, v67
    v_exp_f32 v70, v70
    v_exp_f32 v71, v71
    s_waitcnt vmcnt(4)
    v_mfma_f32_32x32x16_bf16 v[112:127], v[144:147], v[152:155], v[112:127]
    v_cvt_pk_bf16_f32 v38, v68, v69
    v_exp_f32 v72, v72
    v_exp_f32 v73, v73
    v_cvt_pk_bf16_f32 v39, v70, v71
    v_exp_f32 v74, v74
    v_exp_f32 v75, v75
    v_mfma_f32_32x32x16_bf16 v[96:111], v[28:31], v[36:39], v[96:111]
    buffer_load_dwordx4 v228, s[76:79], s74 offen offset:1024 lds
    s_add_u32 s74, s74, 16384
    v_cvt_pk_bf16_f32 v40, v72, v73
    v_exp_f32 v76, v76
    v_exp_f32 v77, v77
    v_cvt_pk_bf16_f32 v41, v74, v75
    v_exp_f32 v78, v78
    v_exp_f32 v79, v79
    v_cvt_pk_bf16_f32 v42, v76, v77
    v_cvt_pk_bf16_f32 v43, v78, v79
    s_setprio 0
    v_mfma_f32_32x32x16_bf16 v[64:79], v[16:19], v[12:15], 0
    ds_read_b128 v[16:19], v236 offset:16896
    v_exp_f32 v48, v48
    v_exp_f32 v49, v49
    v_exp_f32 v50, v50
    v_exp_f32 v51, v51
    v_cvt_pk_bf16_f32 v36, v48, v49
    v_mfma_f32_32x32x16_bf16 v[96:111], v[32:35], v[40:43], v[96:111]
    ds_read_b128 v[28:31], v237 offset:16896
    ds_read_b128 v[32:35], v237 offset:17440
    v_exp_f32 v52, v52
    v_exp_f32 v53, v53
    v_cvt_pk_bf16_f32 v37, v50, v51
    v_exp_f32 v54, v54
    v_exp_f32 v55, v55
    v_mfma_f32_32x32x16_bf16 v[128:143], v[148:151], v[152:155], v[128:143]
    buffer_load_dwordx4 v[152:155], v4, s[64:67], s75 offen offset:0 sc1
    v_cvt_pk_bf16_f32 v38, v52, v53
    v_exp_f32 v56, v56
    v_exp_f32 v57, v57
    v_cvt_pk_bf16_f32 v39, v54, v55
    v_exp_f32 v58, v58
    v_exp_f32 v59, v59
    v_mfma_f32_32x32x16_bf16 v[80:95], v[20:23], v[36:39], v[80:95]
    s_waitcnt vmcnt(4)
    ds_read_b64_tr_b16 v[144:145], v240
    ds_read_b64_tr_b16 v[146:147], v240 offset:1024
    ds_read_b64_tr_b16 v[148:149], v240 offset:256
    ds_read_b64_tr_b16 v[150:151], v240 offset:1280
    v_cvt_pk_bf16_f32 v40, v56, v57
    v_exp_f32 v60, v60
    v_exp_f32 v61, v61
    v_cvt_pk_bf16_f32 v41, v58, v59
    v_exp_f32 v62, v62
    v_exp_f32 v63, v63
    v_cvt_pk_bf16_f32 v42, v60, v61
    v_cvt_pk_bf16_f32 v43, v62, v63
    s_cmp_eq_u32 s87, 0
    s_cbranch_scc1 L_sp_24
    s_setprio 1
L_sp_24:
    s_waitcnt lgkmcnt(0)
    v_mfma_f32_32x32x16_bf16 v[48:63], v[16:19], v[8:11], 0
    s_mov_b32 m0, s62
    v_exp_f32 v64, v64
    v_exp_f32 v65, v65
    v_exp_f32 v66, v66
    v_exp_f32 v67, v67
    v_cvt_pk_bf16_f32 v36, v64, v65
    v_mfma_f32_32x32x16_bf16 v[80:95], v[24:27], v[40:43], v[80:95]
    buffer_load_dwordx4 v241, s[76:79], s74 offen lds
    v_exp_f32 v68, v68
    v_exp_f32 v69, v69
    v_cvt_pk_bf16_f32 v37, v66, v67
    v_exp_f32 v70, v70
    v_exp_f32 v71, v71
    s_waitcnt vmcnt(4)
    v_mfma_f32_32x32x16_bf16 v[112:127], v[144:147], v[156:159], v[112:127]
    v_cvt_pk_bf16_f32 v38, v68, v69
    v_exp_f32 v72, v72
    v_exp_f32 v73, v73
    v_cvt_pk_bf16_f32 v39, v70, v71
    v_exp_f32 v74, v74
    v_exp_f32 v75, v75
    v_mfma_f32_32x32x16_bf16 v[96:111], v[20:23], v[36:39], v[96:111]
    buffer_load_dwordx4 v228, s[76:79], s74 offen offset:1024 lds
    s_add_u32 s74, s74, 16384
    s_cmp_eq_u32 s74, s44
    s_cselect_b32 s88, 294912, 0
    s_sub_u32 s74, s74, s88
    v_cvt_pk_bf16_f32 v40, v72, v73
    v_exp_f32 v76, v76
    v_exp_f32 v77, v77
    v_cvt_pk_bf16_f32 v41, v74, v75
    v_exp_f32 v78, v78
    v_exp_f32 v79, v79
    v_cvt_pk_bf16_f32 v42, v76, v77
    v_cvt_pk_bf16_f32 v43, v78, v79
    v_mfma_f32_32x32x16_bf16 v[64:79], v[16:19], v[12:15], 0
    ds_read_b128 v[16:19], v236 offset:21120
    v_exp_f32 v48, v48
    v_exp_f32 v49, v49
    v_exp_f32 v50, v50
    v_exp_f32 v51, v51
    v_cvt_pk_bf16_f32 v36, v48, v49
    v_mfma_f32_32x32x16_bf16 v[96:111], v[24:27], v[40:43], v[96:111]
    ds_read_b128 v[20:23], v237 offset:21120
    ds_read_b128 v[24:27], v237 offset:21664
    v_exp_f32 v52, v52
    v_exp_f32 v53, v53
    v_cvt_pk_bf16_f32 v37, v50, v51
    v_exp_f32 v54, v54
    v_exp_f32 v55, v55
    v_mfma_f32_32x32x16_bf16 v[128:143], v[148:151], v[156:159], v[128:143]
    buffer_load_dwordx4 v[156:159], v4, s[64:67], s75 offen offset:1024 sc1
    s_add_u32 s75, s75, 2048
    s_cmp_eq_u32 s75, s45
    s_cselect_b32 s88, 18432, 0
    s_sub_u32 s75, s75, s88
    v_cvt_pk_bf16_f32 v38, v52, v53
    v_exp_f32 v56, v56
    v_exp_f32 v57, v57
    v_cvt_pk_bf16_f32 v39, v54, v55
    v_exp_f32 v58, v58
    v_exp_f32 v59, v59
    v_mfma_f32_32x32x16_bf16 v[80:95], v[28:31], v[36:39], v[80:95]
    s_waitcnt vmcnt(4)
    ds_read_b64_tr_b16 v[144:145], v239
    ds_read_b64_tr_b16 v[146:147], v239 offset:1024
    ds_read_b64_tr_b16 v[148:149], v239 offset:256
    ds_read_b64_tr_b16 v[150:151], v239 offset:1280
    v_cvt_pk_bf16_f32 v40, v56, v57
    v_exp_f32 v60, v60
    v_exp_f32 v61, v61
    v_cvt_pk_bf16_f32 v41, v58, v59
    v_exp_f32 v62, v62
    v_exp_f32 v63, v63
    v_cvt_pk_bf16_f32 v42, v60, v61
    v_cvt_pk_bf16_f32 v43, v62, v63
    s_waitcnt lgkmcnt(0)
    v_mfma_f32_32x32x16_bf16 v[48:63], v[16:19], v[8:11], 0
    s_mov_b32 m0, s61
    v_exp_f32 v64, v64
    v_exp_f32 v65, v65
    v_exp_f32 v66, v66
    v_exp_f32 v67, v67
    v_cvt_pk_bf16_f32 v36, v64, v65
    v_mfma_f32_32x32x16_bf16 v[80:95], v[32:35], v[40:43], v[80:95]
    buffer_load_dwordx4 v241, s[76:79], s74 offen lds
    v_exp_f32 v68, v68
    v_exp_f32 v69, v69
    v_cvt_pk_bf16_f32 v37, v66, v67
    v_exp_f32 v70, v70
    v_exp_f32 v71, v71
    s_waitcnt vmcnt(4)
    v_mfma_f32_32x32x16_bf16 v[112:127], v[144:147], v[152:155], v[112:127]
    v_cvt_pk_bf16_f32 v38, v68, v69
    v_exp_f32 v72, v72
    v_exp_f32 v73, v73
    v_cvt_pk_bf16_f32 v39, v70, v71
    v_exp_f32 v74, v74
    v_exp_f32 v75, v75
    v_mfma_f32_32x32x16_bf16 v[96:111], v[28:31], v[36:39], v[96:111]
    buffer_load_dwordx4 v228, s[76:79], s74 offen offset:1024 lds
    s_add_u32 s74, s74, 16384
    v_cvt_pk_bf16_f32 v40, v72, v73
    v_exp_f32 v76, v76
    v_exp_f32 v77, v77
    v_cvt_pk_bf16_f32 v41, v74, v75
    v_exp_f32 v78, v78
    v_exp_f32 v79, v79
    v_cvt_pk_bf16_f32 v42, v76, v77
    v_cvt_pk_bf16_f32 v43, v78, v79
    s_setprio 0
    v_mfma_f32_32x32x16_bf16 v[64:79], v[16:19], v[12:15], 0
    ds_read_b128 v[16:19], v236 offset:25344
    v_exp_f32 v48, v48
    v_exp_f32 v49, v49
    v_exp_f32 v50, v50
    v_exp_f32 v51, v51
    v_cvt_pk_bf16_f32 v36, v48, v49
    v_mfma_f32_32x32x16_bf16 v[96:111], v[32:35], v[40:43], v[96:111]
    ds_read_b128 v[28:31], v237 offset:25344
    ds_read_b128 v[32:35], v237 offset:25888
    v_exp_f32 v52, v52
    v_exp_f32 v53, v53
    v_cvt_pk_bf16_f32 v37, v50, v51
    v_exp_f32 v54, v54
    v_exp_f32 v55, v55
    v_mfma_f32_32x32x16_bf16 v[128:143], v[148:151], v[152:155], v[128:143]
    buffer_load_dwordx4 v[152:155], v4, s[64:67], s75 offen offset:0 sc1
    v_cvt_pk_bf16_f32 v38, v52, v53
    v_exp_f32 v56, v56
    v_exp_f32 v57, v57
    v_cvt_pk_bf16_f32 v39, v54, v55
    v_exp_f32 v58, v58
    v_exp_f32 v59, v59
    v_mfma_f32_32x32x16_bf16 v[80:95], v[20:23], v[36:39], v[80:95]
    s_waitcnt vmcnt(4)
    ds_read_b64_tr_b16 v[144:145], v240
    ds_read_b64_tr_b16 v[146:147], v240 offset:1024
    ds_read_b64_tr_b16 v[148:149], v240 offset:256
    ds_read_b64_tr_b16 v[150:151], v240 offset:1280
    v_cvt_pk_bf16_f32 v40, v56, v57
    v_exp_f32 v60, v60
    v_exp_f32 v61, v61
    v_cvt_pk_bf16_f32 v41, v58, v59
    v_exp_f32 v62, v62
    v_exp_f32 v63, v63
    v_cvt_pk_bf16_f32 v42, v60, v61
    v_cvt_pk_bf16_f32 v43, v62, v63
    s_cmp_eq_u32 s87, 0
    s_cbranch_scc1 L_sp_25
    s_setprio 1
L_sp_25:
    s_waitcnt lgkmcnt(0)
    v_mfma_f32_32x32x16_bf16 v[48:63], v[16:19], v[8:11], 0
    s_mov_b32 m0, s62
    v_exp_f32 v64, v64
    v_exp_f32 v65, v65
    v_exp_f32 v66, v66
    v_exp_f32 v67, v67
    v_cvt_pk_bf16_f32 v36, v64, v65
    v_mfma_f32_32x32x16_bf16 v[80:95], v[24:27], v[40:43], v[80:95]
    buffer_load_dwordx4 v241, s[76:79], s74 offen lds
    v_exp_f32 v68, v68
    v_exp_f32 v69, v69
    v_cvt_pk_bf16_f32 v37, v66, v67
    v_exp_f32 v70, v70
    v_exp_f32 v71, v71
    s_waitcnt vmcnt(4)
    v_mfma_f32_32x32x16_bf16 v[112:127], v[144:147], v[156:159], v[112:127]
    v_cvt_pk_bf16_f32 v38, v68, v69
    v_exp_f32 v72, v72
    v_exp_f32 v73, v73
    v_cvt_pk_bf16_f32 v39, v70, v71
    v_exp_f32 v74, v74
    v_exp_f32 v75, v75
    v_mfma_f32_32x32x16_bf16 v[96:111], v[20:23], v[36:39], v[96:111]
    buffer_load_dwordx4 v228, s[76:79], s74 offen offset:1024 lds
    s_add_u32 s74, s74, 16384
    s_cmp_eq_u32 s74, s44
    s_cselect_b32 s88, 294912, 0
    s_sub_u32 s74, s74, s88
    v_cvt_pk_bf16_f32 v40, v72, v73
    v_exp_f32 v76, v76
    v_exp_f32 v77, v77
    v_cvt_pk_bf16_f32 v41, v74, v75
    v_exp_f32 v78, v78
    v_exp_f32 v79, v79
    v_cvt_pk_bf16_f32 v42, v76, v77
    v_cvt_pk_bf16_f32 v43, v78, v79
    v_mfma_f32_32x32x16_bf16 v[64:79], v[16:19], v[12:15], 0
    ds_read_b128 v[16:19], v236 offset:29568
    v_exp_f32 v48, v48
    v_exp_f32 v49, v49
    v_exp_f32 v50, v50
    v_exp_f32 v51, v51
    v_cvt_pk_bf16_f32 v36, v48, v49
    v_mfma_f32_32x32x16_bf16 v[96:111], v[24:27], v[40:43], v[96:111]
    ds_read_b128 v[20:23], v237 offset:29568
    ds_read_b128 v[24:27], v237 offset:30112
    v_exp_f32 v52, v52
    v_exp_f32 v53, v53
    v_cvt_pk_bf16_f32 v37, v50, v51
    v_exp_f32 v54, v54
    v_exp_f32 v55, v55
    v_mfma_f32_32x32x16_bf16 v[128:143], v[148:151], v[156:159], v[128:143]
    buffer_load_dwordx4 v[204:207], v4, s[64:67], s75 offen offset:1024 sc1
    s_add_u32 s75, s75, 2048
    s_cmp_eq_u32 s75, s45
    s_cselect_b32 s88, 18432, 0
    s_sub_u32 s75, s75, s88
    v_cvt_pk_bf16_f32 v38, v52, v53
    v_exp_f32 v56, v56
    v_exp_f32 v57, v57
    v_cvt_pk_bf16_f32 v39, v54, v55
    v_exp_f32 v58, v58
    v_exp_f32 v59, v59
    v_mfma_f32_32x32x16_bf16 v[80:95], v[28:31], v[36:39], v[80:95]
    s_waitcnt vmcnt(4)
    ds_read_b64_tr_b16 v[144:145], v239
    ds_read_b64_tr_b16 v[146:147], v239 offset:1024
    ds_read_b64_tr_b16 v[148:149], v239 offset:256
    ds_read_b64_tr_b16 v[150:151], v239 offset:1280
    v_cvt_pk_bf16_f32 v40, v56, v57
    v_exp_f32 v60, v60
    v_exp_f32 v61, v61
    v_cvt_pk_bf16_f32 v41, v58, v59
    v_exp_f32 v62, v62
    v_exp_f32 v63, v63
    v_cvt_pk_bf16_f32 v42, v60, v61
    v_cvt_pk_bf16_f32 v43, v62, v63
    s_waitcnt lgkmcnt(0)
    v_mfma_f32_32x32x16_bf16 v[48:63], v[16:19], v[8:11], 0
    s_mov_b32 m0, s61
    v_exp_f32 v64, v64
    v_exp_f32 v65, v65
    v_exp_f32 v66, v66
    v_exp_f32 v67, v67
    v_cvt_pk_bf16_f32 v36, v64, v65
    v_mfma_f32_32x32x16_bf16 v[80:95], v[32:35], v[40:43], v[80:95]
    buffer_load_dwordx4 v241, s[76:79], s74 offen lds
    v_exp_f32 v68, v68
    v_exp_f32 v69, v69
    v_cvt_pk_bf16_f32 v37, v66, v67
    v_exp_f32 v70, v70
    v_exp_f32 v71, v71
    s_waitcnt vmcnt(4)
    v_mfma_f32_32x32x16_bf16 v[112:127], v[144:147], v[152:155], v[112:127]
    v_cvt_pk_bf16_f32 v38, v68, v69
    v_exp_f32 v72, v72
    v_exp_f32 v73, v73
    v_cvt_pk_bf16_f32 v39, v70, v71
    v_exp_f32 v74, v74
    v_exp_f32 v75, v75
    v_mfma_f32_32x32x16_bf16 v[96:111], v[28:31], v[36:39], v[96:111]
    buffer_load_dwordx4 v228, s[76:79], s74 offen offset:1024 lds
    s_add_u32 s74, s74, 16384
    v_cvt_pk_bf16_f32 v40, v72, v73
    v_exp_f32 v76, v76
    v_exp_f32 v77, v77
    v_cvt_pk_bf16_f32 v41, v74, v75
    v_exp_f32 v78, v78
    v_exp_f32 v79, v79
    v_cvt_pk_bf16_f32 v42, v76, v77
    v_cvt_pk_bf16_f32 v43, v78, v79
    s_setprio 0
    v_mfma_f32_32x32x16_bf16 v[64:79], v[16:19], v[12:15], 0
    ds_read_b128 v[16:19], v236 offset:33792
    v_exp_f32 v48, v48
    v_exp_f32 v49, v49
    v_exp_f32 v50, v50
    v_exp_f32 v51, v51
    v_cvt_pk_bf16_f32 v36, v48, v49
    v_mfma_f32_32x32x16_bf16 v[96:111], v[32:35], v[40:43], v[96:111]
    ds_read_b128 v[28:31], v237 offset:33792
    ds_read_b128 v[32:35], v237 offset:34336
    v_exp_f32 v52, v52
    v_exp_f32 v53, v53
    v_cvt_pk_bf16_f32 v37, v50, v51
    v_exp_f32 v54, v54
    v_exp_f32 v55, v55
    v_mfma_f32_32x32x16_bf16 v[128:143], v[148:151], v[152:155], v[128:143]
    buffer_load_dwordx4 v[208:211], v4, s[64:67], s75 offen offset:0 sc1
    v_cvt_pk_bf16_f32 v38, v52, v53
    v_exp_f32 v56, v56
    v_exp_f32 v57, v57
    v_cvt_pk_bf16_f32 v39, v54, v55
    v_exp_f32 v58, v58
    v_exp_f32 v59, v59
    v_mfma_f32_32x32x16_bf16 v[80:95], v[20:23], v[36:39], v[80:95]
    s_waitcnt vmcnt(4)
    ds_read_b64_tr_b16 v[180:181], v240
    ds_read_b64_tr_b16 v[182:183], v240 offset:1024
    ds_read_b64_tr_b16 v[184:185], v240 offset:256
    ds_read_b64_tr_b16 v[186:187], v240 offset:1280
    v_cvt_pk_bf16_f32 v40, v56, v57
    v_exp_f32 v60, v60
    v_exp_f32 v61, v61
    v_cvt_pk_bf16_f32 v41, v58, v59
    v_exp_f32 v62, v62
    v_exp_f32 v63, v63
    v_cvt_pk_bf16_f32 v42, v60, v61
    v_cvt_pk_bf16_f32 v43, v62, v63
    s_cmp_eq_u32 s87, 0
    s_cbranch_scc1 L_sp_26
    s_setprio 1
L_sp_26:
    s_waitcnt lgkmcnt(0)
    v_mfma_f32_32x32x16_bf16 v[48:63], v[16:19], v[8:11], 0
    s_mov_b32 m0, s62
    v_exp_f32 v64, v64
    v_exp_f32 v65, v65
    v_exp_f32 v66, v66
    v_exp_f32 v67, v67
    v_cvt_pk_bf16_f32 v36, v64, v65
    v_mfma_f32_32x32x16_bf16 v[80:95], v[24:27], v[40:43], v[80:95]
    buffer_load_dwordx4 v241, s[76:79], s74 offen lds
    v_exp_f32 v68, v68
    v_exp_f32 v69, v69
    v_cvt_pk_bf16_f32 v37, v66, v67
    v_exp_f32 v70, v70
    v_exp_f32 v71, v71
    v_cvt_pk_bf16_f32 v38, v68, v69
    v_exp_f32 v72, v72
    v_exp_f32 v73, v73
    v_cvt_pk_bf16_f32 v39, v70, v71
    v_exp_f32 v74, v74
    v_exp_f32 v75, v75
    v_mfma_f32_32x32x16_bf16 v[96:111], v[20:23], v[36:39], v[96:111]
    buffer_load_dwordx4 v228, s[76:79], s74 offen offset:1024 lds
    s_add_u32 s74, s74, 16384
    s_cmp_eq_u32 s74, s44
    s_cselect_b32 s88, 294912, 0
    s_sub_u32 s74, s74, s88
    v_cvt_pk_bf16_f32 v40, v72, v73
    v_exp_f32 v76, v76
    v_exp_f32 v77, v77
    v_cvt_pk_bf16_f32 v41, v74, v75
    v_exp_f32 v78, v78
    v_exp_f32 v79, v79
    v_cvt_pk_bf16_f32 v42, v76, v77
    v_cvt_pk_bf16_f32 v43, v78, v79
    v_mfma_f32_32x32x16_bf16 v[64:79], v[16:19], v[12:15], 0
    ds_read_b128 v[16:19], v236 offset:38016
    v_exp_f32 v48, v48
    v_exp_f32 v49, v49
    v_exp_f32 v50, v50
    v_exp_f32 v51, v51
    v_cvt_pk_bf16_f32 v36, v48, v49
    v_mfma_f32_32x32x16_bf16 v[96:111], v[24:27], v[40:43], v[96:111]
    ds_read_b128 v[20:23], v237 offset:38016
    ds_read_b128 v[24:27], v237 offset:38560
    v_exp_f32 v52, v52
    v_exp_f32 v53, v53
    v_cvt_pk_bf16_f32 v37, v50, v51
    v_exp_f32 v54, v54
    v_exp_f32 v55, v55
    buffer_load_dwordx4 v[212:215], v4, s[64:67], s75 offen offset:1024 sc1
    s_add_u32 s75, s75, 2048
    s_cmp_eq_u32 s75, s45
    s_cselect_b32 s88, 18432, 0
    s_sub_u32 s75, s75, s88
    v_cvt_pk_bf16_f32 v38, v52, v53
    v_exp_f32 v56, v56
    v_exp_f32 v57, v57
    v_cvt_pk_bf16_f32 v39, v54, v55
    v_exp_f32 v58, v58
    v_exp_f32 v59, v59
    v_mfma_f32_32x32x16_bf16 v[80:95], v[28:31], v[36:39], v[80:95]
    s_waitcnt vmcnt(4)
    ds_read_b64_tr_b16 v[188:189], v239
    ds_read_b64_tr_b16 v[190:191], v239 offset:1024
    ds_read_b64_tr_b16 v[192:193], v239 offset:256
    ds_read_b64_tr_b16 v[194:195], v239 offset:1280
    v_cvt_pk_bf16_f32 v40, v56, v57
    v_exp_f32 v60, v60
    v_exp_f32 v61, v61
    v_cvt_pk_bf16_f32 v41, v58, v59
    v_exp_f32 v62, v62
    v_exp_f32 v63, v63
    v_cvt_pk_bf16_f32 v42, v60, v61
    v_cvt_pk_bf16_f32 v43, v62, v63
    s_waitcnt lgkmcnt(0)
    v_mfma_f32_32x32x16_bf16 v[48:63], v[16:19], v[8:11], 0
    v_exp_f32 v64, v64
    v_exp_f32 v65, v65
    v_exp_f32 v66, v66
    v_exp_f32 v67, v67
    v_cvt_pk_bf16_f32 v36, v64, v65
    v_mfma_f32_32x32x16_bf16 v[80:95], v[32:35], v[40:43], v[80:95]
    v_exp_f32 v68, v68
    v_exp_f32 v69, v69
    v_cvt_pk_bf16_f32 v37, v66, v67
    v_exp_f32 v70, v70
    v_exp_f32 v71, v71
    v_cvt_pk_bf16_f32 v38, v68, v69
    v_exp_f32 v72, v72
    v_exp_f32 v73, v73
    v_cvt_pk_bf16_f32 v39, v70, v71
    v_exp_f32 v74, v74
    v_exp_f32 v75, v75
    v_mfma_f32_32x32x16_bf16 v[96:111], v[28:31], v[36:39], v[96:111]
    v_cvt_pk_bf16_f32 v40, v72, v73
    v_exp_f32 v76, v76
    v_exp_f32 v77, v77
    v_cvt_pk_bf16_f32 v41, v74, v75
    v_exp_f32 v78, v78
    v_exp_f32 v79, v79
    v_cvt_pk_bf16_f32 v42, v76, v77
    v_cvt_pk_bf16_f32 v43, v78, v79
    s_setprio 0
    v_mfma_f32_32x32x16_bf16 v[64:79], v[16:19], v[12:15], 0
    ds_read_b128 v[16:19], v236 offset:42240
    v_exp_f32 v48, v48
    v_exp_f32 v49, v49
    v_exp_f32 v50, v50
    v_exp_f32 v51, v51
    v_cvt_pk_bf16_f32 v36, v48, v49
    v_mfma_f32_32x32x16_bf16 v[96:111], v[32:35], v[40:43], v[96:111]
    ds_read_b128 v[28:31], v237 offset:42240
    ds_read_b128 v[32:35], v237 offset:42784
    v_exp_f32 v52, v52
    v_exp_f32 v53, v53
    v_cvt_pk_bf16_f32 v37, v50, v51
    v_exp_f32 v54, v54
    v_exp_f32 v55, v55
    v_cvt_pk_bf16_f32 v38, v52, v53
    v_exp_f32 v56, v56
    v_exp_f32 v57, v57
    v_cvt_pk_bf16_f32 v39, v54, v55
    v_exp_f32 v58, v58
    v_exp_f32 v59, v59
    v_mfma_f32_32x32x16_bf16 v[80:95], v[20:23], v[36:39], v[80:95]
    s_waitcnt vmcnt(1)
    ds_read_b64_tr_b16 v[196:197], v240
    ds_read_b64_tr_b16 v[198:199], v240 offset:1024
    ds_read_b64_tr_b16 v[200:201], v240 offset:256
    ds_read_b64_tr_b16 v[202:203], v240 offset:1280
    v_cvt_pk_bf16_f32 v40, v56, v57
    v_exp_f32 v60, v60
    v_exp_f32 v61, v61
    v_cvt_pk_bf16_f32 v41, v58, v59
    v_exp_f32 v62, v62
    v_exp_f32 v63, v63
    v_cvt_pk_bf16_f32 v42, v60, v61
    v_cvt_pk_bf16_f32 v43, v62, v63
    s_cmp_eq_u32 s87, 0
    s_cbranch_scc1 L_sp_27
    s_setprio 1
L_sp_27:
    s_waitcnt lgkmcnt(0)
    v_mfma_f32_32x32x16_bf16 v[48:63], v[16:19], v[8:11], 0
    v_exp_f32 v64, v64
    v_exp_f32 v65, v65
    v_exp_f32 v66, v66
    v_exp_f32 v67, v67
    v_cvt_pk_bf16_f32 v36, v64, v65
    v_mfma_f32_32x32x16_bf16 v[80:95], v[24:27], v[40:43], v[80:95]
    v_exp_f32 v68, v68
    v_exp_f32 v69, v69
    v_cvt_pk_bf16_f32 v37, v66, v67
    v_exp_f32 v70, v70
    v_exp_f32 v71, v71
    v_cvt_pk_bf16_f32 v38, v68, v69
    v_exp_f32 v72, v72
    v_exp_f32 v73, v73
    v_cvt_pk_bf16_f32 v39, v70, v71
    v_exp_f32 v74, v74
    v_exp_f32 v75, v75
    v_mfma_f32_32x32x16_bf16 v[96:111], v[20:23], v[36:39], v[96:111]
    v_cvt_pk_bf16_f32 v40, v72, v73
    v_exp_f32 v76, v76
    v_exp_f32 v77, v77
    v_cvt_pk_bf16_f32 v41, v74, v75
    v_exp_f32 v78, v78
    v_exp_f32 v79, v79
    v_cvt_pk_bf16_f32 v42, v76, v77
    v_cvt_pk_bf16_f32 v43, v78, v79
    s_bitcmp1_b32 s3, 0
    s_cselect_b32 s6, 8192, 0
    s_add_u32 s63, s63, s6
    s_add_u32 s74, s44, s6
    s_mov_b32 s75, s45
    s_lshr_b32 s6, s6, 3
    s_lshl_b32 s7, s60, 14
    s_add_u32 s61, s6, s7
    s_lshr_b32 s7, s7, 1
    s_add_u32 s62, s6, s7
    s_add_u32 s62, s62, 65536
    s_barrier
    s_or_b32 s6, s2, s3
    s_cmp_lg_u32 s6, 0
    s_cbranch_scc1 L_ep0f
    v_and_b32 v5, 7, v1
    v_mul_u32_u24 v6, 6, v5
    v_mul_u32_u24 v5, 5, v5
    v_add_u32 v5, 3, v5
    v_min_u32 v5, v5, v6
    v_lshrrev_b32 v6, 3, v1
    v_lshlrev_b32 v6, 9, v6
    v_lshl_add_u32 v5, v5, 2, v6
    s_mov_b32 s6, 532480
    buffer_load_dword v144, v5, s[20:23], s6 offen sc1
    s_mov_b32 s6, 536576
    buffer_load_dword v145, v5, s[20:23], s6 offen sc1
    s_mov_b32 s6, 540672
    buffer_load_dword v146, v5, s[20:23], s6 offen sc1
    s_mov_b32 s6, 544768
    buffer_load_dword v147, v5, s[20:23], s6 offen sc1
L_ep0f:
    v_mfma_f32_32x32x16_bf16 v[64:79], v[16:19], v[12:15], 0
    ds_read_b128 v[16:19], v236 offset:46464
    s_add_u32 m0, s62, 0
    v_exp_f32 v48, v48
    v_exp_f32 v49, v49
    buffer_load_dwordx4 v241, s[76:79], s74 offen lds
    s_add_u32 s74, s74, 16384
    v_exp_f32 v50, v50
    v_exp_f32 v51, v51
    v_cvt_pk_bf16_f32 v36, v48, v49
    v_mfma_f32_32x32x16_bf16 v[96:111], v[24:27], v[40:43], v[96:111]
    ds_read_b128 v[20:23], v237 offset:46464
    ds_read_b128 v[24:27], v237 offset:47008
    v_exp_f32 v52, v52
    v_exp_f32 v53, v53
    v_cvt_pk_bf16_f32 v37, v50, v51
    v_exp_f32 v54, v54
    v_exp_f32 v55, v55
    v_cvt_pk_bf16_f32 v38, v52, v53
    v_exp_f32 v56, v56
    v_exp_f32 v57, v57
    v_cvt_pk_bf16_f32 v39, v54, v55
    v_exp_f32 v58, v58
    v_exp_f32 v59, v59
    v_mfma_f32_32x32x16_bf16 v[80:95], v[28:31], v[36:39], v[80:95]
    v_cvt_pk_bf16_f32 v40, v56, v57
    v_exp_f32 v60, v60
    v_exp_f32 v61, v61
    v_cvt_pk_bf16_f32 v41, v58, v59
    v_exp_f32 v62, v62
    v_exp_f32 v63, v63
    v_cvt_pk_bf16_f32 v42, v60, v61
    v_cvt_pk_bf16_f32 v43, v62, v63
    s_waitcnt lgkmcnt(0)
    v_mfma_f32_32x32x16_bf16 v[48:63], v[16:19], v[8:11], 0
    s_add_u32 m0, s62, 2048
    v_exp_f32 v64, v64
    v_exp_f32 v65, v65
    buffer_load_dwordx4 v241, s[76:79], s74 offen lds
    s_add_u32 s74, s74, 16384
    v_exp_f32 v66, v66
    v_exp_f32 v67, v67
    v_cvt_pk_bf16_f32 v36, v64, v65
    v_mfma_f32_32x32x16_bf16 v[80:95], v[32:35], v[40:43], v[80:95]
    v_exp_f32 v68, v68
    v_exp_f32 v69, v69
    v_cvt_pk_bf16_f32 v37, v66, v67
    v_exp_f32 v70, v70
    v_exp_f32 v71, v71
    v_cvt_pk_bf16_f32 v38, v68, v69
    v_exp_f32 v72, v72
    v_exp_f32 v73, v73
    v_cvt_pk_bf16_f32 v39, v70, v71
    v_exp_f32 v74, v74
    v_exp_f32 v75, v75
    v_mfma_f32_32x32x16_bf16 v[96:111], v[28:31], v[36:39], v[96:111]
    v_cvt_pk_bf16_f32 v40, v72, v73
    v_exp_f32 v76, v76
    v_exp_f32 v77, v77
    v_cvt_pk_bf16_f32 v41, v74, v75
    v_exp_f32 v78, v78
    v_exp_f32 v79, v79
    v_cvt_pk_bf16_f32 v42, v76, v77
    v_cvt_pk_bf16_f32 v43, v78, v79
    s_setprio 0
    v_mfma_f32_32x32x16_bf16 v[64:79], v[16:19], v[12:15], 0
    ds_read_b128 v[16:19], v236 offset:50688
    s_add_u32 m0, s62, 4096
    v_exp_f32 v48, v48
    v_exp_f32 v49, v49
    buffer_load_dwordx4 v241, s[76:79], s74 offen lds
    s_add_u32 s74, s74, 16384
    v_exp_f32 v50, v50
    v_exp_f32 v51, v51
    v_cvt_pk_bf16_f32 v36, v48, v49
    v_mfma_f32_32x32x16_bf16 v[96:111], v[32:35], v[40:43], v[96:111]
    ds_read_b128 v[28:31], v237 offset:50688
    ds_read_b128 v[32:35], v237 offset:51232
    v_exp_f32 v52, v52
    v_exp_f32 v53, v53
    v_cvt_pk_bf16_f32 v37, v50, v51
    v_exp_f32 v54, v54
    v_exp_f32 v55, v55
    v_cvt_pk_bf16_f32 v38, v52, v53
    v_exp_f32 v56, v56
    v_exp_f32 v57, v57
    v_cvt_pk_bf16_f32 v39, v54, v55
    v_exp_f32 v58, v58
    v_exp_f32 v59, v59
    v_mfma_f32_32x32x16_bf16 v[80:95], v[20:23], v[36:39], v[80:95]
    buffer_load_dwordx4 v[164:167], v4, s[64:67], s75 offen offset:0 sc1
    v_cvt_pk_bf16_f32 v40, v56, v57
    v_exp_f32 v60, v60
    v_exp_f32 v61, v61
    v_cvt_pk_bf16_f32 v41, v58, v59
    v_exp_f32 v62, v62
    v_exp_f32 v63, v63
    v_cvt_pk_bf16_f32 v42, v60, v61
    v_cvt_pk_bf16_f32 v43, v62, v63
    s_cmp_eq_u32 s87, 0
    s_cbranch_scc1 L_sp_28
    s_setprio 1
L_sp_28:
    s_waitcnt lgkmcnt(0)
    v_mfma_f32_32x32x16_bf16 v[48:63], v[16:19], v[8:11], 0
    s_add_u32 m0, s62, 6144
    v_exp_f32 v64, v64
    v_exp_f32 v65, v65
    buffer_load_dwordx4 v241, s[76:79], s74 offen lds
    s_add_u32 s74, s74, 16384
    v_exp_f32 v66, v66
    v_exp_f32 v67, v67
    v_cvt_pk_bf16_f32 v36, v64, v65
    v_mfma_f32_32x32x16_bf16 v[80:95], v[24:27], v[40:43], v[80:95]
    v_exp_f32 v68, v68
    v_exp_f32 v69, v69
    v_cvt_pk_bf16_f32 v37, v66, v67
    v_exp_f32 v70, v70
    v_exp_f32 v71, v71
    v_cvt_pk_bf16_f32 v38, v68, v69
    v_exp_f32 v72, v72
    v_exp_f32 v73, v73
    v_cvt_pk_bf16_f32 v39, v70, v71
    v_exp_f32 v74, v74
    v_exp_f32 v75, v75
    v_mfma_f32_32x32x16_bf16 v[96:111], v[20:23], v[36:39], v[96:111]
    buffer_load_dwordx4 v[168:171], v4, s[64:67], s75 offen offset:1024 sc1
    v_cvt_pk_bf16_f32 v40, v72, v73
    v_exp_f32 v76, v76
    v_exp_f32 v77, v77
    v_cvt_pk_bf16_f32 v41, v74, v75
    v_exp_f32 v78, v78
    v_exp_f32 v79, v79
    v_cvt_pk_bf16_f32 v42, v76, v77
    v_cvt_pk_bf16_f32 v43, v78, v79
    s_or_b32 s6, s2, s3
    s_cmp_lg_u32 s6, 0
    s_cbranch_scc1 L_ep1f
    s_mov_b32 s7, 200000
    s_waitcnt vmcnt(6)
L_pef:
    v_xor_b32 v144, s56, v144
    v_xor_b32 v145, s56, v145
    v_xor_b32 v146, s56, v146
    v_xor_b32 v147, s56, v147
    v_or3_b32 v144, v144, v145, v146
    v_or_b32 v144, v144, v147
    v_cmp_ne_u32 vcc, 0, v144
    s_cbranch_vccz L_eokf
    s_sub_u32 s7, s7, 1
    s_cmp_eq_u32 s7, 0
    s_cbranch_scc1 L_eokf
    s_mov_b32 s6, 532480
    buffer_load_dword v144, v5, s[20:23], s6 offen sc1
    s_mov_b32 s6, 536576
    buffer_load_dword v145, v5, s[20:23], s6 offen sc1
    s_mov_b32 s6, 540672
    buffer_load_dword v146, v5, s[20:23], s6 offen sc1
    s_mov_b32 s6, 544768
    buffer_load_dword v147, v5, s[20:23], s6 offen sc1
    s_waitcnt vmcnt(0)
    s_branch L_pef
L_eokf:
    v_mov_b32 v5, s56
    v_mov_b32 v6, 0
    s_mov_b32 s6, 524288
    buffer_store_dword v5, v6, s[20:23], s6 offen sc1
L_ep1f:
    v_mfma_f32_32x32x16_bf16 v[64:79], v[16:19], v[12:15], 0
    ds_read_b128 v[16:19], v236 offset:54912
    s_add_u32 m0, s61, 0
    v_exp_f32 v48, v48
    v_exp_f32 v49, v49
    buffer_load_dwordx4 v241, s[96:99], s63 offen lds
    s_add_u32 s63, s63, 16384
    v_exp_f32 v50, v50
    v_exp_f32 v51, v51
    v_cvt_pk_bf16_f32 v36, v48, v49
    v_mfma_f32_32x32x16_bf16 v[96:111], v[24:27], v[40:43], v[96:111]
    ds_read_b128 v[20:23], v237 offset:54912
    ds_read_b128 v[24:27], v237 offset:55456
    v_exp_f32 v52, v52
    v_exp_f32 v53, v53
    v_cvt_pk_bf16_f32 v37, v50, v51
    v_exp_f32 v54, v54
    v_exp_f32 v55, v55
    v_cvt_pk_bf16_f32 v38, v52, v53
    v_exp_f32 v56, v56
    v_exp_f32 v57, v57
    v_cvt_pk_bf16_f32 v39, v54, v55
    v_exp_f32 v58, v58
    v_exp_f32 v59, v59
    v_mfma_f32_32x32x16_bf16 v[80:95], v[28:31], v[36:39], v[80:95]
    buffer_load_dwordx4 v[172:175], v4, s[64:67], s75 offen offset:2048 sc1
    v_cvt_pk_bf16_f32 v40, v56, v57
    v_exp_f32 v60, v60
    v_exp_f32 v61, v61
    v_cvt_pk_bf16_f32 v41, v58, v59
    v_exp_f32 v62, v62
    v_exp_f32 v63, v63
    v_cvt_pk_bf16_f32 v42, v60, v61
    v_cvt_pk_bf16_f32 v43, v62, v63
    s_waitcnt lgkmcnt(0)
    v_mfma_f32_32x32x16_bf16 v[48:63], v[16:19], v[8:11], 0
    s_add_u32 m0, s61, 2048
    v_exp_f32 v64, v64
    v_exp_f32 v65, v65
    buffer_load_dwordx4 v241, s[96:99], s63 offen lds
    s_add_u32 s63, s63, 16384
    v_exp_f32 v66, v66
    v_exp_f32 v67, v67
    v_cvt_pk_bf16_f32 v36, v64, v65
    v_mfma_f32_32x32x16_bf16 v[80:95], v[32:35], v[40:43], v[80:95]
    v_exp_f32 v68, v68
    v_exp_f32 v69, v69
    v_cvt_pk_bf16_f32 v37, v66, v67
    v_exp_f32 v70, v70
    v_exp_f32 v71, v71
    v_cvt_pk_bf16_f32 v38, v68, v69
    v_exp_f32 v72, v72
    v_exp_f32 v73, v73
    v_cvt_pk_bf16_f32 v39, v70, v71
    v_exp_f32 v74, v74
    v_exp_f32 v75, v75
    v_mfma_f32_32x32x16_bf16 v[96:111], v[28:31], v[36:39], v[96:111]
    buffer_load_dwordx4 v[176:179], v4, s[64:67], s75 offen offset:3072 sc1
    v_cvt_pk_bf16_f32 v40, v72, v73
    v_exp_f32 v76, v76
    v_exp_f32 v77, v77
    v_cvt_pk_bf16_f32 v41, v74, v75
    v_exp_f32 v78, v78
    v_exp_f32 v79, v79
    v_cvt_pk_bf16_f32 v42, v76, v77
    v_cvt_pk_bf16_f32 v43, v78, v79
    s_setprio 0
    v_mfma_f32_32x32x16_bf16 v[64:79], v[16:19], v[12:15], 0
    ds_read_b128 v[16:19], v236 offset:59136
    s_add_u32 m0, s61, 4096
    v_exp_f32 v48, v48
    v_exp_f32 v49, v49
    buffer_load_dwordx4 v241, s[96:99], s63 offen lds
    s_add_u32 s63, s63, 16384
    v_exp_f32 v50, v50
    v_exp_f32 v51, v51
    v_cvt_pk_bf16_f32 v36, v48, v49
    v_mfma_f32_32x32x16_bf16 v[96:111], v[32:35], v[40:43], v[96:111]
    ds_read_b128 v[28:31], v237 offset:59136
    ds_read_b128 v[32:35], v237 offset:59680
    v_exp_f32 v52, v52
    v_exp_f32 v53, v53
    v_cvt_pk_bf16_f32 v37, v50, v51
    v_exp_f32 v54, v54
    v_exp_f32 v55, v55
    v_cvt_pk_bf16_f32 v38, v52, v53
    v_exp_f32 v56, v56
    v_exp_f32 v57, v57
    v_cvt_pk_bf16_f32 v39, v54, v55
    v_exp_f32 v58, v58
    v_exp_f32 v59, v59
    v_mfma_f32_32x32x16_bf16 v[80:95], v[20:23], v[36:39], v[80:95]
    v_cvt_pk_bf16_f32 v40, v56, v57
    v_exp_f32 v60, v60
    v_exp_f32 v61, v61
    v_cvt_pk_bf16_f32 v41, v58, v59
    v_exp_f32 v62, v62
    v_exp_f32 v63, v63
    v_cvt_pk_bf16_f32 v42, v60, v61
    v_cvt_pk_bf16_f32 v43, v62, v63
    s_cmp_eq_u32 s87, 0
    s_cbranch_scc1 L_sp_29
    s_setprio 1
L_sp_29:
    s_waitcnt lgkmcnt(0)
    v_mfma_f32_32x32x16_bf16 v[48:63], v[16:19], v[8:11], 0
    s_add_u32 m0, s61, 6144
    v_exp_f32 v64, v64
    v_exp_f32 v65, v65
    buffer_load_dwordx4 v241, s[96:99], s63 offen lds
    s_add_u32 s63, s63, 16384
    v_exp_f32 v66, v66
    v_exp_f32 v67, v67
    v_cvt_pk_bf16_f32 v36, v64, v65
    v_mfma_f32_32x32x16_bf16 v[80:95], v[24:27], v[40:43], v[80:95]
    v_exp_f32 v68, v68
    v_exp_f32 v69, v69
    v_cvt_pk_bf16_f32 v37, v66, v67
    v_exp_f32 v70, v70
    v_exp_f32 v71, v71
    v_cvt_pk_bf16_f32 v38, v68, v69
    v_exp_f32 v72, v72
    v_exp_f32 v73, v73
    v_cvt_pk_bf16_f32 v39, v70, v71
    v_exp_f32 v74, v74
    v_exp_f32 v75, v75
    v_mfma_f32_32x32x16_bf16 v[96:111], v[20:23], v[36:39], v[96:111]
    v_cvt_pk_bf16_f32 v40, v72, v73
    v_exp_f32 v76, v76
    v_exp_f32 v77, v77
    v_cvt_pk_bf16_f32 v41, v74, v75
    v_exp_f32 v78, v78
    v_exp_f32 v79, v79
    v_cvt_pk_bf16_f32 v42, v76, v77
    v_cvt_pk_bf16_f32 v43, v78, v79
    v_mfma_f32_32x32x16_bf16 v[64:79], v[16:19], v[12:15], 0
    ds_read_b128 v[16:19], v236 offset:63360
    s_add_u32 m0, s61, 8192
    v_exp_f32 v48, v48
    v_exp_f32 v49, v49
    buffer_load_dwordx4 v241, s[96:99], s63 offen lds
    s_add_u32 s63, s63, 16384
    v_exp_f32 v50, v50
    v_exp_f32 v51, v51
    v_cvt_pk_bf16_f32 v36, v48, v49
    v_mfma_f32_32x32x16_bf16 v[96:111], v[24:27], v[40:43], v[96:111]
    ds_read_b128 v[20:23], v237 offset:63360
    ds_read_b128 v[24:27], v237 offset:63904
    v_exp_f32 v52, v52
    v_exp_f32 v53, v53
    v_cvt_pk_bf16_f32 v37, v50, v51
    v_exp_f32 v54, v54
    v_exp_f32 v55, v55
    v_cvt_pk_bf16_f32 v38, v52, v53
    v_exp_f32 v56, v56
    v_exp_f32 v57, v57
    v_cvt_pk_bf16_f32 v39, v54, v55
    v_exp_f32 v58, v58
    v_exp_f32 v59, v59
    v_mfma_f32_32x32x16_bf16 v[80:95], v[28:31], v[36:39], v[80:95]
    v_cvt_pk_bf16_f32 v40, v56, v57
    v_exp_f32 v60, v60
    v_exp_f32 v61, v61
    v_cvt_pk_bf16_f32 v41, v58, v59
    v_exp_f32 v62, v62
    v_exp_f32 v63, v63
    v_cvt_pk_bf16_f32 v42, v60, v61
    v_cvt_pk_bf16_f32 v43, v62, v63
    s_waitcnt lgkmcnt(0)
    v_mfma_f32_32x32x16_bf16 v[48:63], v[16:19], v[8:11], 0
    s_add_u32 m0, s61, 10240
    v_exp_f32 v64, v64
    v_exp_f32 v65, v65
    buffer_load_dwordx4 v241, s[96:99], s63 offen lds
    s_add_u32 s63, s63, 16384
    v_exp_f32 v66, v66
    v_exp_f32 v67, v67
    v_cvt_pk_bf16_f32 v36, v64, v65
    v_mfma_f32_32x32x16_bf16 v[80:95], v[32:35], v[40:43], v[80:95]
    v_exp_f32 v68, v68
    v_exp_f32 v69, v69
    v_cvt_pk_bf16_f32 v37, v66, v67
    v_exp_f32 v70, v70
    v_exp_f32 v71, v71
    v_cvt_pk_bf16_f32 v38, v68, v69
    v_exp_f32 v72, v72
    v_exp_f32 v73, v73
    v_cvt_pk_bf16_f32 v39, v70, v71
    v_exp_f32 v74, v74
    v_exp_f32 v75, v75
    v_mfma_f32_32x32x16_bf16 v[96:111], v[28:31], v[36:39], v[96:111]
    v_cvt_pk_bf16_f32 v40, v72, v73
    v_exp_f32 v76, v76
    v_exp_f32 v77, v77
    v_cvt_pk_bf16_f32 v41, v74, v75
    v_exp_f32 v78, v78
    v_exp_f32 v79, v79
    v_cvt_pk_bf16_f32 v42, v76, v77
    v_cvt_pk_bf16_f32 v43, v78, v79
    v_add_u32 v236, 63360, v236
    v_add_u32 v237, 63360, v237
    s_setprio 0
    v_mfma_f32_32x32x16_bf16 v[64:79], v[16:19], v[12:15], 0
    ds_read_b128 v[16:19], v236 offset:4224
    s_add_u32 m0, s61, 12288
    v_exp_f32 v48, v48
    v_exp_f32 v49, v49
    buffer_load_dwordx4 v241, s[96:99], s63 offen lds
    s_add_u32 s63, s63, 16384
    v_exp_f32 v50, v50
    v_exp_f32 v51, v51
    v_cvt_pk_bf16_f32 v36, v48, v49
    v_mfma_f32_32x32x16_bf16 v[96:111], v[32:35], v[40:43], v[96:111]
    ds_read_b128 v[28:31], v237 offset:4224
    ds_read_b128 v[32:35], v237 offset:4768
    v_exp_f32 v52, v52
    v_exp_f32 v53, v53
    v_cvt_pk_bf16_f32 v37, v50, v51
    v_exp_f32 v54, v54
    v_exp_f32 v55, v55
    v_cvt_pk_bf16_f32 v38, v52, v53
    v_exp_f32 v56, v56
    v_exp_f32 v57, v57
    v_cvt_pk_bf16_f32 v39, v54, v55
    v_exp_f32 v58, v58
    v_exp_f32 v59, v59
    v_mfma_f32_32x32x16_bf16 v[80:95], v[20:23], v[36:39], v[80:95]
    v_cvt_pk_bf16_f32 v40, v56, v57
    v_exp_f32 v60, v60
    v_exp_f32 v61, v61
    v_cvt_pk_bf16_f32 v41, v58, v59
    v_exp_f32 v62, v62
    v_exp_f32 v63, v63
    v_cvt_pk_bf16_f32 v42, v60, v61
    v_cvt_pk_bf16_f32 v43, v62, v63
    s_cmp_eq_u32 s87, 0
    s_cbranch_scc1 L_sp_30
    s_setprio 1
L_sp_30:
    s_waitcnt lgkmcnt(0)
    v_mfma_f32_32x32x16_bf16 v[48:63], v[16:19], v[8:11], 0
    s_add_u32 m0, s61, 14336
    v_exp_f32 v64, v64
    v_exp_f32 v65, v65
    buffer_load_dwordx4 v241, s[96:99], s63 offen lds
    s_add_u32 s63, s63, 16384
    v_exp_f32 v66, v66
    v_exp_f32 v67, v67
    v_cvt_pk_bf16_f32 v36, v64, v65
    v_mfma_f32_32x32x16_bf16 v[80:95], v[24:27], v[40:43], v[80:95]
    v_exp_f32 v68, v68
    v_exp_f32 v69, v69
    v_cvt_pk_bf16_f32 v37, v66, v67
    v_exp_f32 v70, v70
    v_exp_f32 v71, v71
    v_cvt_pk_bf16_f32 v38, v68, v69
    v_exp_f32 v72, v72
    v_exp_f32 v73, v73
    v_cvt_pk_bf16_f32 v39, v70, v71
    v_exp_f32 v74, v74
    v_exp_f32 v75, v75
    v_mfma_f32_32x32x16_bf16 v[96:111], v[20:23], v[36:39], v[96:111]
    v_cvt_pk_bf16_f32 v40, v72, v73
    v_exp_f32 v76, v76
    v_exp_f32 v77, v77
    v_cvt_pk_bf16_f32 v41, v74, v75
    v_exp_f32 v78, v78
    v_exp_f32 v79, v79
    v_cvt_pk_bf16_f32 v42, v76, v77
    v_cvt_pk_bf16_f32 v43, v78, v79
    v_mfma_f32_32x32x16_bf16 v[64:79], v[16:19], v[12:15], 0
    v_exp_f32 v48, v48
    v_exp_f32 v49, v49
    v_exp_f32 v50, v50
    v_exp_f32 v51, v51
    v_cvt_pk_bf16_f32 v36, v48, v49
    v_mfma_f32_32x32x16_bf16 v[96:111], v[24:27], v[40:43], v[96:111]
    v_exp_f32 v52, v52
    v_exp_f32 v53, v53
    v_cvt_pk_bf16_f32 v37, v50, v51
    v_exp_f32 v54, v54
    v_exp_f32 v55, v55
    v_cvt_pk_bf16_f32 v38, v52, v53
    v_exp_f32 v56, v56
    v_exp_f32 v57, v57
    v_cvt_pk_bf16_f32 v39, v54, v55
    v_exp_f32 v58, v58
    v_exp_f32 v59, v59
    v_mfma_f32_32x32x16_bf16 v[80:95], v[28:31], v[36:39], v[80:95]
    v_cvt_pk_bf16_f32 v40, v56, v57
    v_exp_f32 v60, v60
    v_exp_f32 v61, v61
    v_cvt_pk_bf16_f32 v41, v58, v59
    v_exp_f32 v62, v62
    v_exp_f32 v63, v63
    v_cvt_pk_bf16_f32 v42, v60, v61
    v_cvt_pk_bf16_f32 v43, v62, v63
    v_exp_f32 v64, v64
    v_exp_f32 v65, v65
    v_exp_f32 v66, v66
    v_exp_f32 v67, v67
    v_cvt_pk_bf16_f32 v36, v64, v65
    v_mfma_f32_32x32x16_bf16 v[80:95], v[32:35], v[40:43], v[80:95]
    v_exp_f32 v68, v68
    v_exp_f32 v69, v69
    v_cvt_pk_bf16_f32 v37, v66, v67
    v_exp_f32 v70, v70
    v_exp_f32 v71, v71
    v_cvt_pk_bf16_f32 v38, v68, v69
    v_exp_f32 v72, v72
    v_exp_f32 v73, v73
    v_cvt_pk_bf16_f32 v39, v70, v71
    v_exp_f32 v74, v74
    v_exp_f32 v75, v75
    v_mfma_f32_32x32x16_bf16 v[96:111], v[28:31], v[36:39], v[96:111]
    v_cvt_pk_bf16_f32 v40, v72, v73
    v_exp_f32 v76, v76
    v_exp_f32 v77, v77
    v_cvt_pk_bf16_f32 v41, v74, v75
    v_exp_f32 v78, v78
    v_exp_f32 v79, v79
    v_cvt_pk_bf16_f32 v42, v76, v77
    v_cvt_pk_bf16_f32 v43, v78, v79
    s_setprio 0
    s_nop 0
    v_mfma_f32_32x32x16_bf16 v[96:111], v[32:35], v[40:43], v[96:111]
    s_xor_b32 s6, s3, 4
    s_mul_i32 s6, s6, 3072
    s_add_u32 s6, s6, 135168
    v_add_u32 v2, s6, v4
    s_mul_i32 s6, s3, 3072
    s_add_u32 s6, s6, 135168
    v_add_u32 v3, s6, v4
    v_cmp_lt_u32 vcc, 31, v1
    s_cmp_eq_u32 s87, 0
    s_cbranch_scc0 L_c1
    s_nop 2
    v_cndmask_b32 v104, v104, v108, vcc
    ds_write_b128 v2, v[96:99]
    ds_write_b128 v2, v[100:103] offset:1024
    ds_write_b128 v2, v[104:107] offset:2048
    v_cndmask_b32 v88, v88, v92, vcc
    s_branch L_c2
L_c1:
    s_nop 2
    v_cndmask_b32 v88, v88, v92, vcc
    ds_write_b128 v2, v[80:83]
    ds_write_b128 v2, v[84:87] offset:1024
    ds_write_b128 v2, v[88:91] offset:2048
    v_cndmask_b32 v88, v104, v108, vcc
    v_mov_b64 v[80:81], v[96:97]
    v_mov_b64 v[82:83], v[98:99]
    v_mov_b64 v[84:85], v[100:101]
    v_mov_b64 v[86:87], v[102:103]
L_c2:
    s_waitcnt vmcnt(0) lgkmcnt(0)
    s_barrier
    ds_read_b128 v[48:51], v3
    ds_read_b128 v[52:55], v3 offset:1024
    ds_read_b32 v56, v3 offset:2048
    s_waitcnt lgkmcnt(0)
    v_add_f32 v5, v88, v56
    v_pk_add_f32 v[80:81], v[80:81], v[48:49]
    v_pk_add_f32 v[82:83], v[82:83], v[50:51]
    v_pk_add_f32 v[84:85], v[84:85], v[52:53]
    v_pk_add_f32 v[86:87], v[86:87], v[54:55]
L_fin:
    v_rcp_f32 v6, v5
    s_lshl_b32 s6, s69, 15
    v_pk_mul_f32 v[80:81], v[80:81], v[6:7] op_sel_hi:[1,0]
    v_pk_mul_f32 v[82:83], v[82:83], v[6:7] op_sel_hi:[1,0]
    v_pk_mul_f32 v[84:85], v[84:85], v[6:7] op_sel_hi:[1,0]
    v_pk_mul_f32 v[86:87], v[86:87], v[6:7] op_sel_hi:[1,0]
    v_cvt_pk_bf16_f32 v36, v80, v81
    v_cvt_pk_bf16_f32 v37, v82, v83
    v_cvt_pk_bf16_f32 v38, v84, v85
    v_cvt_pk_bf16_f32 v39, v86, v87
    buffer_store_dwordx4 v[36:39], v4, s[20:23], s68 offen sc1
    s_lshl_b32 s7, s60, 13
    s_add_u32 s6, s6, s7
    s_add_u32 s30, s6, 3145728
    s_add_u32 s31, s30, 4096
    s_lshl_b32 s6, s3, 11
    v_subrev_u32 v240, s6, v240
    s_lshl_b32 s6, s60, 14
    v_add_u32 v239, s6, v240
    s_lshr_b32 s6, s6, 1
    s_add_u32 s6, s6, 65536
    v_add_u32 v240, s6, v240
    ds_read_b64_tr_b16 v[8:9], v239 offset:0
    ds_read_b64_tr_b16 v[10:11], v239 offset:1024
    ds_read_b64_tr_b16 v[12:13], v239 offset:256
    ds_read_b64_tr_b16 v[14:15], v239 offset:1280
    ds_read_b64_tr_b16 v[16:17], v239 offset:2048
    ds_read_b64_tr_b16 v[18:19], v239 offset:3072
    ds_read_b64_tr_b16 v[20:21], v239 offset:2304
    ds_read_b64_tr_b16 v[22:23], v239 offset:3328
    ds_read_b64_tr_b16 v[24:25], v239 offset:4096
    ds_read_b64_tr_b16 v[26:27], v239 offset:5120
    ds_read_b64_tr_b16 v[28:29], v239 offset:4352
    ds_read_b64_tr_b16 v[30:31], v239 offset:5376
    s_waitcnt lgkmcnt(8)
    ds_read_b64_tr_b16 v[40:41], v239 offset:6144
    ds_read_b64_tr_b16 v[42:43], v239 offset:7168
    ds_read_b64_tr_b16 v[44:45], v239 offset:6400
    ds_read_b64_tr_b16 v[46:47], v239 offset:7424
    s_waitcnt lgkmcnt(8)
    ds_read_b64_tr_b16 v[144:145], v239 offset:8192
    ds_read_b64_tr_b16 v[146:147], v239 offset:9216
    ds_read_b64_tr_b16 v[148:149], v239 offset:8448
    ds_read_b64_tr_b16 v[150:151], v239 offset:9472
    s_waitcnt lgkmcnt(8)
    ds_read_b64_tr_b16 v[152:153], v239 offset:10240
    ds_read_b64_tr_b16 v[154:155], v239 offset:11264
    ds_read_b64_tr_b16 v[156:157], v239 offset:10496
    ds_read_b64_tr_b16 v[158:159], v239 offset:11520
    s_waitcnt lgkmcnt(8)
    ds_read_b64_tr_b16 v[216:217], v239 offset:12288
    ds_read_b64_tr_b16 v[218:219], v239 offset:13312
    ds_read_b64_tr_b16 v[220:221], v239 offset:12544
    ds_read_b64_tr_b16 v[222:223], v239 offset:13568
    s_waitcnt lgkmcnt(8)
    ds_read_b64_tr_b16 v[32:33], v239 offset:14336
    ds_read_b64_tr_b16 v[34:35], v239 offset:15360
    ds_read_b64_tr_b16 v[36:37], v239 offset:14592
    ds_read_b64_tr_b16 v[38:39], v239 offset:15616
    s_waitcnt lgkmcnt(8)
    ds_read_b64_tr_b16 v[80:81], v240 offset:0
    ds_read_b64_tr_b16 v[82:83], v240 offset:1024
    ds_read_b64_tr_b16 v[84:85], v240 offset:256
    ds_read_b64_tr_b16 v[86:87], v240 offset:1280
    s_waitcnt lgkmcnt(8)
    ds_read_b64_tr_b16 v[88:89], v240 offset:2048
    ds_read_b64_tr_b16 v[90:91], v240 offset:3072
    ds_read_b64_tr_b16 v[92:93], v240 offset:2304
    ds_read_b64_tr_b16 v[94:95], v240 offset:3328
    s_waitcnt lgkmcnt(8)
    s_barrier
    ds_read_b64_tr_b16 v[96:97], v240 offset:4096
    ds_read_b64_tr_b16 v[98:99], v240 offset:5120
    ds_read_b64_tr_b16 v[100:101], v240 offset:4352
    ds_read_b64_tr_b16 v[102:103], v240 offset:5376
    s_waitcnt lgkmcnt(8)
    ds_read_b64_tr_b16 v[104:105], v240 offset:6144
    ds_read_b64_tr_b16 v[106:107], v240 offset:7168
    ds_read_b64_tr_b16 v[108:109], v240 offset:6400
    ds_read_b64_tr_b16 v[110:111], v240 offset:7424
    v_mfma_f32_32x32x16_bf16 v[112:127], v[80:83], v[164:167], v[112:127]
    v_mfma_f32_32x32x16_bf16 v[128:143], v[84:87], v[164:167], v[128:143]
    s_waitcnt lgkmcnt(8)
    v_mfma_f32_32x32x16_bf16 v[112:127], v[88:91], v[168:171], v[112:127]
    v_mfma_f32_32x32x16_bf16 v[128:143], v[92:95], v[168:171], v[128:143]
    s_waitcnt lgkmcnt(4)
    v_mfma_f32_32x32x16_bf16 v[112:127], v[96:99], v[172:175], v[112:127]
    v_mfma_f32_32x32x16_bf16 v[128:143], v[100:103], v[172:175], v[128:143]
    buffer_load_dwordx4 v[48:51], v4, s[20:23], s30 offen offset:0 sc1
    buffer_load_dwordx4 v[52:55], v4, s[20:23], s30 offen offset:1024 sc1
    buffer_load_dwordx4 v[56:59], v4, s[20:23], s30 offen offset:2048 sc1
    buffer_load_dwordx4 v[60:63], v4, s[20:23], s30 offen offset:3072 sc1
    buffer_load_dwordx4 v[64:67], v4, s[20:23], s31 offen offset:0 sc1
    buffer_load_dwordx4 v[68:71], v4, s[20:23], s31 offen offset:1024 sc1
    buffer_load_dwordx4 v[72:75], v4, s[20:23], s31 offen offset:2048 sc1
    buffer_load_dwordx4 v[76:79], v4, s[20:23], s31 offen offset:3072 sc1
    s_waitcnt lgkmcnt(0)
    v_mfma_f32_32x32x16_bf16 v[112:127], v[104:107], v[176:179], v[112:127]
    v_mfma_f32_32x32x16_bf16 v[128:143], v[108:111], v[176:179], v[128:143]
    v_mfma_f32_32x32x16_bf16 v[112:127], v[180:183], v[204:207], v[112:127]
    v_mfma_f32_32x32x16_bf16 v[128:143], v[184:187], v[204:207], v[128:143]
    v_mfma_f32_32x32x16_bf16 v[112:127], v[188:191], v[208:211], v[112:127]
    v_mfma_f32_32x32x16_bf16 v[128:143], v[192:195], v[208:211], v[128:143]
    v_mfma_f32_32x32x16_bf16 v[112:127], v[196:199], v[212:215], v[112:127]
    v_mfma_f32_32x32x16_bf16 v[128:143], v[200:203], v[212:215], v[128:143]
    s_mov_b32 s12, s50
    s_mov_b32 s13, s51
    s_mov_b32 s14, 2097152
    s_mov_b32 s15, 0x00020000
    v_lshlrev_b32 v224, 16, v160
    v_and_b32 v225, 0xffff0000, v160
    v_lshlrev_b32 v226, 16, v161
    v_and_b32 v227, 0xffff0000, v161
    v_lshlrev_b32 v228, 16, v162
    v_and_b32 v229, 0xffff0000, v162
    v_lshlrev_b32 v230, 16, v163
    v_and_b32 v231, 0xffff0000, v163
    v_and_b32 v5, 31, v1
    v_lshrrev_b32 v6, 5, v1
    v_and_b32 v7, 7, v1
    v_xor_b32 v6, v6, v7
    v_lshlrev_b32 v6, 4, v6
    v_lshl_add_u32 v5, v5, 8, v6
    s_lshl_b32 s6, s3, 13
    v_add_u32 v80, s6, v5
    v_xor_b32 v81, 32, v80
    v_xor_b32 v82, 64, v80
    v_xor_b32 v83, 96, v80
    v_lshrrev_b32 v5, 3, v1
    v_lshlrev_b32 v6, 1, v7
    v_xor_b32 v6, v6, v5
    v_lshlrev_b32 v6, 4, v6
    v_lshl_add_u32 v5, v5, 8, v6
    s_and_b32 s6, s3, 1
    s_lshl_b32 s6, s6, 2
    s_add_u32 s6, s6, s60
    s_lshl_b32 s6, s6, 11
    v_add_u32 v84, s6, v5
    v_xor_b32 v85, 16, v84
    s_mov_b32 s7, 200000
    s_waitcnt vmcnt(7)
L_oc0:
    v_max3_u32 v5, v48, v49, v50
    v_max_u32 v5, v5, v51
    v_cmp_eq_u32 vcc, -1, v5
    s_cbranch_vccnz L_or0
L_og0:
    v_mfma_f32_32x32x16_bf16 v[112:127], v[8:11], v[48:51], v[112:127]
    v_mfma_f32_32x32x16_bf16 v[128:143], v[12:15], v[48:51], v[128:143]
    s_waitcnt vmcnt(6)
L_oc1:
    v_max3_u32 v5, v52, v53, v54
    v_max_u32 v5, v5, v55
    v_cmp_eq_u32 vcc, -1, v5
    s_cbranch_vccnz L_or1
L_og1:
    v_mfma_f32_32x32x16_bf16 v[112:127], v[16:19], v[52:55], v[112:127]
    v_mfma_f32_32x32x16_bf16 v[128:143], v[20:23], v[52:55], v[128:143]
    s_waitcnt vmcnt(5)
L_oc2:
    v_max3_u32 v5, v56, v57, v58
    v_max_u32 v5, v5, v59
    v_cmp_eq_u32 vcc, -1, v5
    s_cbranch_vccnz L_or2
L_og2:
    v_mfma_f32_32x32x16_bf16 v[112:127], v[24:27], v[56:59], v[112:127]
    v_mfma_f32_32x32x16_bf16 v[128:143], v[28:31], v[56:59], v[128:143]
    s_waitcnt vmcnt(4)
L_oc3:
    v_max3_u32 v5, v60, v61, v62
    v_max_u32 v5, v5, v63
    v_cmp_eq_u32 vcc, -1, v5
    s_cbranch_vccnz L_or3
L_og3:
    v_mfma_f32_32x32x16_bf16 v[112:127], v[40:43], v[60:63], v[112:127]
    v_mfma_f32_32x32x16_bf16 v[128:143], v[44:47], v[60:63], v[128:143]
    s_waitcnt vmcnt(3)
L_oc4:
    v_max3_u32 v5, v64, v65, v66
    v_max_u32 v5, v5, v67
    v_cmp_eq_u32 vcc, -1, v5
    s_cbranch_vccnz L_or4
L_og4:
    v_mfma_f32_32x32x16_bf16 v[112:127], v[144:147], v[64:67], v[112:127]
    v_mfma_f32_32x32x16_bf16 v[128:143], v[148:151], v[64:67], v[128:143]
    s_waitcnt vmcnt(2)
L_oc5:
    v_max3_u32 v5, v68, v69, v70
    v_max_u32 v5, v5, v71
    v_cmp_eq_u32 vcc, -1, v5
    s_cbranch_vccnz L_or5
L_og5:
    v_mfma_f32_32x32x16_bf16 v[112:127], v[152:155], v[68:71], v[112:127]
    v_mfma_f32_32x32x16_bf16 v[128:143], v[156:159], v[68:71], v[128:143]
    s_waitcnt vmcnt(1)
L_oc6:
    v_max3_u32 v5, v72, v73, v74
    v_max_u32 v5, v5, v75
    v_cmp_eq_u32 vcc, -1, v5
    s_cbranch_vccnz L_or6
L_og6:
    v_mfma_f32_32x32x16_bf16 v[112:127], v[216:219], v[72:75], v[112:127]
    v_mfma_f32_32x32x16_bf16 v[128:143], v[220:223], v[72:75], v[128:143]
    s_waitcnt vmcnt(0)
L_oc7:
    v_max3_u32 v5, v76, v77, v78
    v_max_u32 v5, v5, v79
    v_cmp_eq_u32 vcc, -1, v5
    s_cbranch_vccnz L_or7
L_og7:
    v_mfma_f32_32x32x16_bf16 v[112:127], v[32:35], v[76:79], v[112:127]
    v_mfma_f32_32x32x16_bf16 v[128:143], v[36:39], v[76:79], v[128:143]
    s_nop 10
    ds_write_b128 v80, v[112:115] offset:0
    ds_write_b128 v81, v[116:119] offset:0
    ds_write_b128 v82, v[120:123] offset:0
    ds_write_b128 v83, v[124:127] offset:0
    ds_write_b128 v80, v[128:131] offset:128
    ds_write_b128 v81, v[132:135] offset:128
    ds_write_b128 v82, v[136:139] offset:128
    ds_write_b128 v83, v[140:143] offset:128
    s_waitcnt lgkmcnt(0)
    s_barrier
    ds_read_b128 v[48:51], v84 offset:0
    ds_read_b128 v[52:55], v85 offset:0
    ds_read_b128 v[56:59], v84 offset:16384
    ds_read_b128 v[60:63], v85 offset:16384
    ds_read_b128 v[64:67], v84 offset:32768
    ds_read_b128 v[68:71], v85 offset:32768
    ds_read_b128 v[72:75], v84 offset:49152
    ds_read_b128 v[76:79], v85 offset:49152
    s_waitcnt lgkmcnt(6)
    v_pk_add_f32 v[224:225], v[224:225], v[48:49]
    v_pk_add_f32 v[226:227], v[226:227], v[50:51]
    v_pk_add_f32 v[228:229], v[228:229], v[52:53]
    v_pk_add_f32 v[230:231], v[230:231], v[54:55]
    s_waitcnt lgkmcnt(4)
    v_pk_add_f32 v[224:225], v[224:225], v[56:57]
    v_pk_add_f32 v[226:227], v[226:227], v[58:59]
    v_pk_add_f32 v[228:229], v[228:229], v[60:61]
    v_pk_add_f32 v[230:231], v[230:231], v[62:63]
    s_waitcnt lgkmcnt(2)
    v_pk_add_f32 v[224:225], v[224:225], v[64:65]
    v_pk_add_f32 v[226:227], v[226:227], v[66:67]
    v_pk_add_f32 v[228:229], v[228:229], v[68:69]
    v_pk_add_f32 v[230:231], v[230:231], v[70:71]
    s_waitcnt lgkmcnt(0)
    v_pk_add_f32 v[224:225], v[224:225], v[72:73]
    v_pk_add_f32 v[226:227], v[226:227], v[74:75]
    v_pk_add_f32 v[228:229], v[228:229], v[76:77]
    v_pk_add_f32 v[230:231], v[230:231], v[78:79]
    v_cvt_pk_bf16_f32 v24, v224, v225
    v_cvt_pk_bf16_f32 v25, v226, v227
    v_cvt_pk_bf16_f32 v26, v228, v229
    v_cvt_pk_bf16_f32 v27, v230, v231
    buffer_store_dwordx4 v[24:27], v242, s[12:15], 0 offen nt
L_done:
    s_endpgm
L_or0:
    s_sub_u32 s7, s7, 1
    s_cmp_eq_u32 s7, 0
    s_cbranch_scc1 L_og0
    s_waitcnt vmcnt(0)
    buffer_load_dwordx4 v[48:51], v4, s[20:23], s30 offen offset:0 sc1
    buffer_load_dwordx4 v[52:55], v4, s[20:23], s30 offen offset:1024 sc1
    buffer_load_dwordx4 v[56:59], v4, s[20:23], s30 offen offset:2048 sc1
    buffer_load_dwordx4 v[60:63], v4, s[20:23], s30 offen offset:3072 sc1
    buffer_load_dwordx4 v[64:67], v4, s[20:23], s31 offen offset:0 sc1
    buffer_load_dwordx4 v[68:71], v4, s[20:23], s31 offen offset:1024 sc1
    buffer_load_dwordx4 v[72:75], v4, s[20:23], s31 offen offset:2048 sc1
    buffer_load_dwordx4 v[76:79], v4, s[20:23], s31 offen offset:3072 sc1
    s_waitcnt vmcnt(7)
    s_branch L_oc0
L_or1:
    s_sub_u32 s7, s7, 1
    s_cmp_eq_u32 s7, 0
    s_cbranch_scc1 L_og1
    s_waitcnt vmcnt(0)
    buffer_load_dwordx4 v[52:55], v4, s[20:23], s30 offen offset:1024 sc1
    buffer_load_dwordx4 v[56:59], v4, s[20:23], s30 offen offset:2048 sc1
    buffer_load_dwordx4 v[60:63], v4, s[20:23], s30 offen offset:3072 sc1
    buffer_load_dwordx4 v[64:67], v4, s[20:23], s31 offen offset:0 sc1
    buffer_load_dwordx4 v[68:71], v4, s[20:23], s31 offen offset:1024 sc1
    buffer_load_dwordx4 v[72:75], v4, s[20:23], s31 offen offset:2048 sc1
    buffer_load_dwordx4 v[76:79], v4, s[20:23], s31 offen offset:3072 sc1
    s_waitcnt vmcnt(6)
    s_branch L_oc1
L_or2:
    s_sub_u32 s7, s7, 1
    s_cmp_eq_u32 s7, 0
    s_cbranch_scc1 L_og2
    s_waitcnt vmcnt(0)
    buffer_load_dwordx4 v[56:59], v4, s[20:23], s30 offen offset:2048 sc1
    buffer_load_dwordx4 v[60:63], v4, s[20:23], s30 offen offset:3072 sc1
    buffer_load_dwordx4 v[64:67], v4, s[20:23], s31 offen offset:0 sc1
    buffer_load_dwordx4 v[68:71], v4, s[20:23], s31 offen offset:1024 sc1
    buffer_load_dwordx4 v[72:75], v4, s[20:23], s31 offen offset:2048 sc1
    buffer_load_dwordx4 v[76:79], v4, s[20:23], s31 offen offset:3072 sc1
    s_waitcnt vmcnt(5)
    s_branch L_oc2
L_or3:
    s_sub_u32 s7, s7, 1
    s_cmp_eq_u32 s7, 0
    s_cbranch_scc1 L_og3
    s_waitcnt vmcnt(0)
    buffer_load_dwordx4 v[60:63], v4, s[20:23], s30 offen offset:3072 sc1
    buffer_load_dwordx4 v[64:67], v4, s[20:23], s31 offen offset:0 sc1
    buffer_load_dwordx4 v[68:71], v4, s[20:23], s31 offen offset:1024 sc1
    buffer_load_dwordx4 v[72:75], v4, s[20:23], s31 offen offset:2048 sc1
    buffer_load_dwordx4 v[76:79], v4, s[20:23], s31 offen offset:3072 sc1
    s_waitcnt vmcnt(4)
    s_branch L_oc3
L_or4:
    s_sub_u32 s7, s7, 1
    s_cmp_eq_u32 s7, 0
    s_cbranch_scc1 L_og4
    s_waitcnt vmcnt(0)
    buffer_load_dwordx4 v[64:67], v4, s[20:23], s31 offen offset:0 sc1
    buffer_load_dwordx4 v[68:71], v4, s[20:23], s31 offen offset:1024 sc1
    buffer_load_dwordx4 v[72:75], v4, s[20:23], s31 offen offset:2048 sc1
    buffer_load_dwordx4 v[76:79], v4, s[20:23], s31 offen offset:3072 sc1
    s_waitcnt vmcnt(3)
    s_branch L_oc4
L_or5:
    s_sub_u32 s7, s7, 1
    s_cmp_eq_u32 s7, 0
    s_cbranch_scc1 L_og5
    s_waitcnt vmcnt(0)
    buffer_load_dwordx4 v[68:71], v4, s[20:23], s31 offen offset:1024 sc1
    buffer_load_dwordx4 v[72:75], v4, s[20:23], s31 offen offset:2048 sc1
    buffer_load_dwordx4 v[76:79], v4, s[20:23], s31 offen offset:3072 sc1
    s_waitcnt vmcnt(2)
    s_branch L_oc5
L_or6:
    s_sub_u32 s7, s7, 1
    s_cmp_eq_u32 s7, 0
    s_cbranch_scc1 L_og6
    s_waitcnt vmcnt(0)
    buffer_load_dwordx4 v[72:75], v4, s[20:23], s31 offen offset:2048 sc1
    buffer_load_dwordx4 v[76:79], v4, s[20:23], s31 offen offset:3072 sc1
    s_waitcnt vmcnt(1)
    s_branch L_oc6
L_or7:
    s_sub_u32 s7, s7, 1
    s_cmp_eq_u32 s7, 0
    s_cbranch_scc1 L_og7
    s_waitcnt vmcnt(0)
    buffer_load_dwordx4 v[76:79], v4, s[20:23], s31 offen offset:3072 sc1
    s_waitcnt vmcnt(0)
    s_branch L_oc7
L_slow:
    s_setprio 0
    s_waitcnt lgkmcnt(0)
    s_nop 15
    v_mov_b32 v28, 0xff61b1e6
    v_mov_b32 v80, 0
    v_mov_b32 v81, 0
    v_mov_b32 v82, 0
    v_mov_b32 v83, 0
    v_mov_b32 v84, 0
    v_mov_b32 v85, 0
    v_mov_b32 v86, 0
    v_mov_b32 v87, 0
    v_mov_b32 v88, 0
    v_mov_b32 v89, 0
    v_mov_b32 v90, 0
    v_mov_b32 v91, 0
    v_mov_b32 v92, 0
    v_mov_b32 v93, 0
    v_mov_b32 v94, 0
    v_mov_b32 v95, 0
    v_mov_b32 v29, 0xff61b1e6
    v_mov_b32 v96, 0
    v_mov_b32 v97, 0
    v_mov_b32 v98, 0
    v_mov_b32 v99, 0
    v_mov_b32 v100, 0
    v_mov_b32 v101, 0
    v_mov_b32 v102, 0
    v_mov_b32 v103, 0
    v_mov_b32 v104, 0
    v_mov_b32 v105, 0
    v_mov_b32 v106, 0
    v_mov_b32 v107, 0
    v_mov_b32 v108, 0
    v_mov_b32 v109, 0
    v_mov_b32 v110, 0
    v_mov_b32 v111, 0
    s_cmp_eq_u32 s24, 0
    s_cbranch_scc0 L_snokv
    s_add_u32 m0, s80, s81
    s_add_u32 s88, s82, s81
    s_add_u32 s81, s81, 4096
    buffer_load_dwordx4 v4, s[20:23], s88 offen sc1 lds
    s_cmp_eq_u32 s81, 102400
    s_cselect_b32 s81, 0, s81
    s_add_u32 m0, s80, s81
    s_add_u32 s88, s82, s81
    s_add_u32 s81, s81, 4096
    buffer_load_dwordx4 v4, s[20:23], s88 offen sc1 lds
    s_cmp_eq_u32 s81, 102400
    s_cselect_b32 s81, 0, s81
    s_add_u32 m0, s80, s81
    s_add_u32 s88, s82, s81
    s_add_u32 s81, s81, 4096
    buffer_load_dwordx4 v4, s[20:23], s88 offen sc1 lds
    s_cmp_eq_u32 s81, 102400
    s_cselect_b32 s81, 0, s81
    s_add_u32 m0, s80, s81
    s_add_u32 s88, s82, s81
    s_add_u32 s81, s81, 4096
    buffer_load_dwordx4 v4, s[20:23], s88 offen sc1 lds
    s_cmp_eq_u32 s81, 102400
    s_cselect_b32 s81, 0, s81
    s_add_u32 m0, s80, s81
    s_add_u32 s88, s82, s81
    s_add_u32 s81, s81, 4096
    buffer_load_dwordx4 v4, s[20:23], s88 offen sc1 lds
    s_cmp_eq_u32 s81, 102400
    s_cselect_b32 s81, 0, s81
    s_add_u32 m0, s80, s81
    s_add_u32 s88, s82, s81
    s_add_u32 s81, s81, 4096
    buffer_load_dwordx4 v4, s[20:23], s88 offen sc1 lds
    s_cmp_eq_u32 s81, 102400
    s_cselect_b32 s81, 0, s81
    s_add_u32 m0, s80, s81
    s_add_u32 s88, s82, s81
    s_add_u32 s81, s81, 4096
    buffer_load_dwordx4 v4, s[20:23], s88 offen sc1 lds
    s_cmp_eq_u32 s81, 102400
    s_cselect_b32 s81, 0, s81
    s_add_u32 m0, s80, s81
    s_add_u32 s88, s82, s81
    s_add_u32 s81, s81, 4096
    buffer_load_dwordx4 v4, s[20:23], s88 offen sc1 lds
    s_cmp_eq_u32 s81, 102400
    s_cselect_b32 s81, 0, s81
    s_add_u32 m0, s80, s81
    s_add_u32 s88, s82, s81
    s_add_u32 s81, s81, 4096
    buffer_load_dwordx4 v4, s[20:23], s88 offen sc1 lds
    s_cmp_eq_u32 s81, 102400
    s_cselect_b32 s81, 0, s81
    s_add_u32 m0, s80, s81
    s_add_u32 s88, s82, s81
    s_add_u32 s81, s81, 4096
    buffer_load_dwordx4 v4, s[20:23], s88 offen sc1 lds
    s_cmp_eq_u32 s81, 102400
    s_cselect_b32 s81, 0, s81
    s_add_u32 m0, s80, s81
    s_add_u32 s88, s82, s81
    s_add_u32 s81, s81, 4096
    buffer_load_dwordx4 v4, s[20:23], s88 offen sc1 lds
    s_cmp_eq_u32 s81, 102400
    s_cselect_b32 s81, 0, s81
    s_add_u32 m0, s80, s81
    s_add_u32 s88, s82, s81
    s_add_u32 s81, s81, 4096
    buffer_load_dwordx4 v4, s[20:23], s88 offen sc1 lds
    s_cmp_eq_u32 s81, 102400
    s_cselect_b32 s81, 0, s81
    s_add_u32 m0, s80, s81
    s_add_u32 s88, s82, s81
    s_add_u32 s81, s81, 4096
    buffer_load_dwordx4 v4, s[20:23], s88 offen sc1 lds
    s_cmp_eq_u32 s81, 102400
    s_cselect_b32 s81, 0, s81
    s_add_u32 m0, s80, s81
    s_add_u32 s88, s82, s81
    s_add_u32 s81, s81, 4096
    buffer_load_dwordx4 v4, s[20:23], s88 offen sc1 lds
    s_cmp_eq_u32 s81, 102400
    s_cselect_b32 s81, 0, s81
    s_add_u32 m0, s80, s81
    s_add_u32 s88, s82, s81
    s_add_u32 s81, s81, 4096
    buffer_load_dwordx4 v4, s[20:23], s88 offen sc1 lds
    s_cmp_eq_u32 s81, 102400
    s_cselect_b32 s81, 0, s81
    s_add_u32 m0, s80, s81
    s_add_u32 s88, s82, s81
    s_add_u32 s81, s81, 4096
    buffer_load_dwordx4 v4, s[20:23], s88 offen sc1 lds
    s_cmp_eq_u32 s81, 102400
    s_cselect_b32 s81, 0, s81
    s_add_u32 m0, s80, s81
    s_add_u32 s88, s82, s81
    s_add_u32 s81, s81, 4096
    buffer_load_dwordx4 v4, s[20:23], s88 offen sc1 lds
    s_cmp_eq_u32 s81, 102400
    s_cselect_b32 s81, 0, s81
L_snokv:
    s_cmp_eq_u32 s89, 0
    s_cbranch_scc1 L_nohfs
    v_mov_b32 v5, s56
    v_lshlrev_b32 v6, 8, v1
    s_mov_b32 exec_lo, s89
    s_mov_b32 exec_hi, 0
    s_waitcnt vmcnt(0)
    buffer_store_dword v5, v6, s[20:23], s100 offen sc1
    s_mov_b64 exec, -1
    s_mov_b32 s89, 0
L_nohfs:
    buffer_load_dwordx4 v[160:163], v242, s[8:11], 0 offen
    s_mov_b32 s30, 6
L_sla:
    ds_read_b128 v[16:19], v236
    ds_read_b128 v[20:23], v237
    ds_read_b128 v[24:27], v237 offset:544
    s_waitcnt lgkmcnt(0)
    v_mfma_f32_32x32x16_bf16 v[48:63], v[16:19], v[8:11], 0
    s_nop 15
    v_max3_f32 v30, v48, v49, v28
    v_max3_f32 v30, v50, v51, v30
    v_max3_f32 v30, v52, v53, v30
    v_max3_f32 v30, v54, v55, v30
    v_max3_f32 v30, v56, v57, v30
    v_max3_f32 v30, v58, v59, v30
    v_max3_f32 v30, v60, v61, v30
    v_max3_f32 v30, v62, v63, v30
    v_mov_b32 v31, v30
    s_nop 1
    v_permlane32_swap_b32 v30, v31
    s_nop 1
    v_max_f32 v30, v30, v31
    v_sub_f32 v31, v28, v30
    v_exp_f32 v31, v31
    v_mov_b32 v28, v30
    v_sub_f32 v48, v48, v28
    v_sub_f32 v49, v49, v28
    v_sub_f32 v50, v50, v28
    v_sub_f32 v51, v51, v28
    v_sub_f32 v52, v52, v28
    v_sub_f32 v53, v53, v28
    v_sub_f32 v54, v54, v28
    v_sub_f32 v55, v55, v28
    v_sub_f32 v56, v56, v28
    v_sub_f32 v57, v57, v28
    v_sub_f32 v58, v58, v28
    v_sub_f32 v59, v59, v28
    v_sub_f32 v60, v60, v28
    v_sub_f32 v61, v61, v28
    v_sub_f32 v62, v62, v28
    v_sub_f32 v63, v63, v28
    v_exp_f32 v48, v48
    v_exp_f32 v49, v49
    v_exp_f32 v50, v50
    v_exp_f32 v51, v51
    v_exp_f32 v52, v52
    v_exp_f32 v53, v53
    v_exp_f32 v54, v54
    v_exp_f32 v55, v55
    v_exp_f32 v56, v56
    v_exp_f32 v57, v57
    v_exp_f32 v58, v58
    v_exp_f32 v59, v59
    v_exp_f32 v60, v60
    v_exp_f32 v61, v61
    v_exp_f32 v62, v62
    v_exp_f32 v63, v63
    v_mul_f32 v80, v80, v31
    v_mul_f32 v81, v81, v31
    v_mul_f32 v82, v82, v31
    v_mul_f32 v83, v83, v31
    v_mul_f32 v84, v84, v31
    v_mul_f32 v85, v85, v31
    v_mul_f32 v86, v86, v31
    v_mul_f32 v87, v87, v31
    v_mul_f32 v88, v88, v31
    v_mul_f32 v89, v89, v31
    v_mul_f32 v90, v90, v31
    v_mul_f32 v91, v91, v31
    v_mul_f32 v92, v92, v31
    v_mul_f32 v93, v93, v31
    v_mul_f32 v94, v94, v31
    v_mul_f32 v95, v95, v31
    v_cvt_pk_bf16_f32 v36, v48, v49
    v_cvt_pk_bf16_f32 v37, v50, v51
    v_cvt_pk_bf16_f32 v38, v52, v53
    v_cvt_pk_bf16_f32 v39, v54, v55
    v_cvt_pk_bf16_f32 v40, v56, v57
    v_cvt_pk_bf16_f32 v41, v58, v59
    v_cvt_pk_bf16_f32 v42, v60, v61
    v_cvt_pk_bf16_f32 v43, v62, v63
    s_nop 1
    v_mfma_f32_32x32x16_bf16 v[80:95], v[20:23], v[36:39], v[80:95]
    v_mfma_f32_32x32x16_bf16 v[80:95], v[24:27], v[40:43], v[80:95]
    v_mfma_f32_32x32x16_bf16 v[48:63], v[16:19], v[12:15], 0
    s_nop 15
    v_max3_f32 v30, v48, v49, v29
    v_max3_f32 v30, v50, v51, v30
    v_max3_f32 v30, v52, v53, v30
    v_max3_f32 v30, v54, v55, v30
    v_max3_f32 v30, v56, v57, v30
    v_max3_f32 v30, v58, v59, v30
    v_max3_f32 v30, v60, v61, v30
    v_max3_f32 v30, v62, v63, v30
    v_mov_b32 v31, v30
    s_nop 1
    v_permlane32_swap_b32 v30, v31
    s_nop 1
    v_max_f32 v30, v30, v31
    v_sub_f32 v31, v29, v30
    v_exp_f32 v31, v31
    v_mov_b32 v29, v30
    v_sub_f32 v48, v48, v29
    v_sub_f32 v49, v49, v29
    v_sub_f32 v50, v50, v29
    v_sub_f32 v51, v51, v29
    v_sub_f32 v52, v52, v29
    v_sub_f32 v53, v53, v29
    v_sub_f32 v54, v54, v29
    v_sub_f32 v55, v55, v29
    v_sub_f32 v56, v56, v29
    v_sub_f32 v57, v57, v29
    v_sub_f32 v58, v58, v29
    v_sub_f32 v59, v59, v29
    v_sub_f32 v60, v60, v29
    v_sub_f32 v61, v61, v29
    v_sub_f32 v62, v62, v29
    v_sub_f32 v63, v63, v29
    v_exp_f32 v48, v48
    v_exp_f32 v49, v49
    v_exp_f32 v50, v50
    v_exp_f32 v51, v51
    v_exp_f32 v52, v52
    v_exp_f32 v53, v53
    v_exp_f32 v54, v54
    v_exp_f32 v55, v55
    v_exp_f32 v56, v56
    v_exp_f32 v57, v57
    v_exp_f32 v58, v58
    v_exp_f32 v59, v59
    v_exp_f32 v60, v60
    v_exp_f32 v61, v61
    v_exp_f32 v62, v62
    v_exp_f32 v63, v63
    v_mul_f32 v96, v96, v31
    v_mul_f32 v97, v97, v31
    v_mul_f32 v98, v98, v31
    v_mul_f32 v99, v99, v31
    v_mul_f32 v100, v100, v31
    v_mul_f32 v101, v101, v31
    v_mul_f32 v102, v102, v31
    v_mul_f32 v103, v103, v31
    v_mul_f32 v104, v104, v31
    v_mul_f32 v105, v105, v31
    v_mul_f32 v106, v106, v31
    v_mul_f32 v107, v107, v31
    v_mul_f32 v108, v108, v31
    v_mul_f32 v109, v109, v31
    v_mul_f32 v110, v110, v31
    v_mul_f32 v111, v111, v31
    v_cvt_pk_bf16_f32 v36, v48, v49
    v_cvt_pk_bf16_f32 v37, v50, v51
    v_cvt_pk_bf16_f32 v38, v52, v53
    v_cvt_pk_bf16_f32 v39, v54, v55
    v_cvt_pk_bf16_f32 v40, v56, v57
    v_cvt_pk_bf16_f32 v41, v58, v59
    v_cvt_pk_bf16_f32 v42, v60, v61
    v_cvt_pk_bf16_f32 v43, v62, v63
    s_nop 1
    v_mfma_f32_32x32x16_bf16 v[96:111], v[20:23], v[36:39], v[96:111]
    v_mfma_f32_32x32x16_bf16 v[96:111], v[24:27], v[40:43], v[96:111]
    v_add_u32 v236, 4224, v236
    v_add_u32 v237, 4224, v237
    s_sub_u32 s30, s30, 1
    s_cmp_lg_u32 s30, 0
    s_cbranch_scc1 L_sla
    s_waitcnt vmcnt(0)
    s_barrier
    s_mov_b32 s30, 26
L_slb:
    ds_read_b128 v[16:19], v236
    ds_read_b128 v[20:23], v237
    ds_read_b128 v[24:27], v237 offset:544
    s_waitcnt lgkmcnt(0)
    v_mfma_f32_32x32x16_bf16 v[48:63], v[16:19], v[8:11], 0
    s_nop 15
    v_max3_f32 v30, v48, v49, v28
    v_max3_f32 v30, v50, v51, v30
    v_max3_f32 v30, v52, v53, v30
    v_max3_f32 v30, v54, v55, v30
    v_max3_f32 v30, v56, v57, v30
    v_max3_f32 v30, v58, v59, v30
    v_max3_f32 v30, v60, v61, v30
    v_max3_f32 v30, v62, v63, v30
    v_mov_b32 v31, v30
    s_nop 1
    v_permlane32_swap_b32 v30, v31
    s_nop 1
    v_max_f32 v30, v30, v31
    v_sub_f32 v31, v28, v30
    v_exp_f32 v31, v31
    v_mov_b32 v28, v30
    v_sub_f32 v48, v48, v28
    v_sub_f32 v49, v49, v28
    v_sub_f32 v50, v50, v28
    v_sub_f32 v51, v51, v28
    v_sub_f32 v52, v52, v28
    v_sub_f32 v53, v53, v28
    v_sub_f32 v54, v54, v28
    v_sub_f32 v55, v55, v28
    v_sub_f32 v56, v56, v28
    v_sub_f32 v57, v57, v28
    v_sub_f32 v58, v58, v28
    v_sub_f32 v59, v59, v28
    v_sub_f32 v60, v60, v28
    v_sub_f32 v61, v61, v28
    v_sub_f32 v62, v62, v28
    v_sub_f32 v63, v63, v28
    v_exp_f32 v48, v48
    v_exp_f32 v49, v49
    v_exp_f32 v50, v50
    v_exp_f32 v51, v51
    v_exp_f32 v52, v52
    v_exp_f32 v53, v53
    v_exp_f32 v54, v54
    v_exp_f32 v55, v55
    v_exp_f32 v56, v56
    v_exp_f32 v57, v57
    v_exp_f32 v58, v58
    v_exp_f32 v59, v59
    v_exp_f32 v60, v60
    v_exp_f32 v61, v61
    v_exp_f32 v62, v62
    v_exp_f32 v63, v63
    v_mul_f32 v80, v80, v31
    v_mul_f32 v81, v81, v31
    v_mul_f32 v82, v82, v31
    v_mul_f32 v83, v83, v31
    v_mul_f32 v84, v84, v31
    v_mul_f32 v85, v85, v31
    v_mul_f32 v86, v86, v31
    v_mul_f32 v87, v87, v31
    v_mul_f32 v88, v88, v31
    v_mul_f32 v89, v89, v31
    v_mul_f32 v90, v90, v31
    v_mul_f32 v91, v91, v31
    v_mul_f32 v92, v92, v31
    v_mul_f32 v93, v93, v31
    v_mul_f32 v94, v94, v31
    v_mul_f32 v95, v95, v31
    v_cvt_pk_bf16_f32 v36, v48, v49
    v_cvt_pk_bf16_f32 v37, v50, v51
    v_cvt_pk_bf16_f32 v38, v52, v53
    v_cvt_pk_bf16_f32 v39, v54, v55
    v_cvt_pk_bf16_f32 v40, v56, v57
    v_cvt_pk_bf16_f32 v41, v58, v59
    v_cvt_pk_bf16_f32 v42, v60, v61
    v_cvt_pk_bf16_f32 v43, v62, v63
    s_nop 1
    v_mfma_f32_32x32x16_bf16 v[80:95], v[20:23], v[36:39], v[80:95]
    v_mfma_f32_32x32x16_bf16 v[80:95], v[24:27], v[40:43], v[80:95]
    v_mfma_f32_32x32x16_bf16 v[48:63], v[16:19], v[12:15], 0
    s_nop 15
    v_max3_f32 v30, v48, v49, v29
    v_max3_f32 v30, v50, v51, v30
    v_max3_f32 v30, v52, v53, v30
    v_max3_f32 v30, v54, v55, v30
    v_max3_f32 v30, v56, v57, v30
    v_max3_f32 v30, v58, v59, v30
    v_max3_f32 v30, v60, v61, v30
    v_max3_f32 v30, v62, v63, v30
    v_mov_b32 v31, v30
    s_nop 1
    v_permlane32_swap_b32 v30, v31
    s_nop 1
    v_max_f32 v30, v30, v31
    v_sub_f32 v31, v29, v30
    v_exp_f32 v31, v31
    v_mov_b32 v29, v30
    v_sub_f32 v48, v48, v29
    v_sub_f32 v49, v49, v29
    v_sub_f32 v50, v50, v29
    v_sub_f32 v51, v51, v29
    v_sub_f32 v52, v52, v29
    v_sub_f32 v53, v53, v29
    v_sub_f32 v54, v54, v29
    v_sub_f32 v55, v55, v29
    v_sub_f32 v56, v56, v29
    v_sub_f32 v57, v57, v29
    v_sub_f32 v58, v58, v29
    v_sub_f32 v59, v59, v29
    v_sub_f32 v60, v60, v29
    v_sub_f32 v61, v61, v29
    v_sub_f32 v62, v62, v29
    v_sub_f32 v63, v63, v29
    v_exp_f32 v48, v48
    v_exp_f32 v49, v49
    v_exp_f32 v50, v50
    v_exp_f32 v51, v51
    v_exp_f32 v52, v52
    v_exp_f32 v53, v53
    v_exp_f32 v54, v54
    v_exp_f32 v55, v55
    v_exp_f32 v56, v56
    v_exp_f32 v57, v57
    v_exp_f32 v58, v58
    v_exp_f32 v59, v59
    v_exp_f32 v60, v60
    v_exp_f32 v61, v61
    v_exp_f32 v62, v62
    v_exp_f32 v63, v63
    v_mul_f32 v96, v96, v31
    v_mul_f32 v97, v97, v31
    v_mul_f32 v98, v98, v31
    v_mul_f32 v99, v99, v31
    v_mul_f32 v100, v100, v31
    v_mul_f32 v101, v101, v31
    v_mul_f32 v102, v102, v31
    v_mul_f32 v103, v103, v31
    v_mul_f32 v104, v104, v31
    v_mul_f32 v105, v105, v31
    v_mul_f32 v106, v106, v31
    v_mul_f32 v107, v107, v31
    v_mul_f32 v108, v108, v31
    v_mul_f32 v109, v109, v31
    v_mul_f32 v110, v110, v31
    v_mul_f32 v111, v111, v31
    v_cvt_pk_bf16_f32 v36, v48, v49
    v_cvt_pk_bf16_f32 v37, v50, v51
    v_cvt_pk_bf16_f32 v38, v52, v53
    v_cvt_pk_bf16_f32 v39, v54, v55
    v_cvt_pk_bf16_f32 v40, v56, v57
    v_cvt_pk_bf16_f32 v41, v58, v59
    v_cvt_pk_bf16_f32 v42, v60, v61
    v_cvt_pk_bf16_f32 v43, v62, v63
    s_nop 1
    v_mfma_f32_32x32x16_bf16 v[96:111], v[20:23], v[36:39], v[96:111]
    v_mfma_f32_32x32x16_bf16 v[96:111], v[24:27], v[40:43], v[96:111]
    v_add_u32 v236, 4224, v236
    v_add_u32 v237, 4224, v237
    s_sub_u32 s30, s30, 1
    s_cmp_lg_u32 s30, 0
    s_cbranch_scc1 L_slb
    s_lshl_b32 s6, s69, 8
    s_add_u32 s6, s6, 532480
    v_min_u32 v5, 42, v1
    v_lshlrev_b32 v5, 2, v5
    buffer_load_dword v6, v5, s[20:23], s6 offen sc1
    s_mov_b32 m0, s61
    s_nop 0
    buffer_load_dwordx4 v241, s[76:79], s74 offen lds
    buffer_load_dwordx4 v228, s[76:79], s74 offen offset:1024 lds
    s_add_u32 s74, s74, 16384
    s_mov_b32 m0, s62
    s_nop 0
    buffer_load_dwordx4 v241, s[76:79], s74 offen lds
    buffer_load_dwordx4 v228, s[76:79], s74 offen offset:1024 lds
    s_add_u32 s74, s74, 16384
    s_cmp_eq_u32 s74, s44
    s_cselect_b32 s88, 294912, 0
    s_sub_u32 s74, s74, s88
    s_mov_b32 s7, 200000
    s_waitcnt vmcnt(4)
L_phs:
    v_cmp_ne_u32 vcc, s56, v6
    s_cbranch_vccz L_hoks
    s_sub_u32 s7, s7, 1
    s_cmp_eq_u32 s7, 0
    s_cbranch_scc1 L_hoks
    s_sleep 1
    buffer_load_dword v6, v5, s[20:23], s6 offen sc1
    s_waitcnt vmcnt(0)
    s_branch L_phs
L_hoks:
    s_waitcnt lgkmcnt(0)
    s_nop 0
    buffer_load_dwordx4 v[152:155], v4, s[64:67], s75 offen offset:0 sc1
    buffer_load_dwordx4 v[156:159], v4, s[64:67], s75 offen offset:1024 sc1
    s_add_u32 s75, s75, 2048
    s_cmp_eq_u32 s75, s45
    s_cselect_b32 s88, 18432, 0
    s_sub_u32 s75, s75, s88
    s_nop 0
    s_waitcnt vmcnt(4)
    ds_read_b64_tr_b16 v[144:145], v239
    ds_read_b64_tr_b16 v[146:147], v239 offset:1024
    ds_read_b64_tr_b16 v[148:149], v239 offset:256
    ds_read_b64_tr_b16 v[150:151], v239 offset:1280
    s_waitcnt lgkmcnt(0)
    s_mov_b32 m0, s61
    s_nop 0
    buffer_load_dwordx4 v241, s[76:79], s74 offen lds
    s_waitcnt vmcnt(2)
    v_mfma_f32_32x32x16_bf16 v[112:127], v[144:147], v[152:155], 0
    buffer_load_dwordx4 v228, s[76:79], s74 offen offset:1024 lds
    s_add_u32 s74, s74, 16384
    s_nop 0
    v_mfma_f32_32x32x16_bf16 v[128:143], v[148:151], v[152:155], 0
    buffer_load_dwordx4 v[152:155], v4, s[64:67], s75 offen offset:0 sc1
    s_waitcnt vmcnt(4)
    ds_read_b64_tr_b16 v[144:145], v240
    ds_read_b64_tr_b16 v[146:147], v240 offset:1024
    ds_read_b64_tr_b16 v[148:149], v240 offset:256
    ds_read_b64_tr_b16 v[150:151], v240 offset:1280
    s_waitcnt lgkmcnt(0)
    s_mov_b32 m0, s62
    s_nop 0
    buffer_load_dwordx4 v241, s[76:79], s74 offen lds
    s_waitcnt vmcnt(4)
    v_mfma_f32_32x32x16_bf16 v[112:127], v[144:147], v[156:159], v[112:127]
    buffer_load_dwordx4 v228, s[76:79], s74 offen offset:1024 lds
    s_add_u32 s74, s74, 16384
    s_cmp_eq_u32 s74, s44
    s_cselect_b32 s88, 294912, 0
    s_sub_u32 s74, s74, s88
    s_nop 0
    v_mfma_f32_32x32x16_bf16 v[128:143], v[148:151], v[156:159], v[128:143]
    buffer_load_dwordx4 v[156:159], v4, s[64:67], s75 offen offset:1024 sc1
    s_add_u32 s75, s75, 2048
    s_cmp_eq_u32 s75, s45
    s_cselect_b32 s88, 18432, 0
    s_sub_u32 s75, s75, s88
    s_waitcnt vmcnt(4)
    ds_read_b64_tr_b16 v[144:145], v239
    ds_read_b64_tr_b16 v[146:147], v239 offset:1024
    ds_read_b64_tr_b16 v[148:149], v239 offset:256
    ds_read_b64_tr_b16 v[150:151], v239 offset:1280
    s_waitcnt lgkmcnt(0)
    s_mov_b32 m0, s61
    s_nop 0
    buffer_load_dwordx4 v241, s[76:79], s74 offen lds
    s_waitcnt vmcnt(4)
    v_mfma_f32_32x32x16_bf16 v[112:127], v[144:147], v[152:155], v[112:127]
    buffer_load_dwordx4 v228, s[76:79], s74 offen offset:1024 lds
    s_add_u32 s74, s74, 16384
    s_nop 0
    v_mfma_f32_32x32x16_bf16 v[128:143], v[148:151], v[152:155], v[128:143]
    buffer_load_dwordx4 v[152:155], v4, s[64:67], s75 offen offset:0 sc1
    s_waitcnt vmcnt(4)
    ds_read_b64_tr_b16 v[144:145], v240
    ds_read_b64_tr_b16 v[146:147], v240 offset:1024
    ds_read_b64_tr_b16 v[148:149], v240 offset:256
    ds_read_b64_tr_b16 v[150:151], v240 offset:1280
    s_waitcnt lgkmcnt(0)
    s_mov_b32 m0, s62
    s_nop 0
    buffer_load_dwordx4 v241, s[76:79], s74 offen lds
    s_waitcnt vmcnt(4)
    v_mfma_f32_32x32x16_bf16 v[112:127], v[144:147], v[156:159], v[112:127]
    buffer_load_dwordx4 v228, s[76:79], s74 offen offset:1024 lds
    s_add_u32 s74, s74, 16384
    s_cmp_eq_u32 s74, s44
    s_cselect_b32 s88, 294912, 0
    s_sub_u32 s74, s74, s88
    s_nop 0
    v_mfma_f32_32x32x16_bf16 v[128:143], v[148:151], v[156:159], v[128:143]
    buffer_load_dwordx4 v[156:159], v4, s[64:67], s75 offen offset:1024 sc1
    s_add_u32 s75, s75, 2048
    s_cmp_eq_u32 s75, s45
    s_cselect_b32 s88, 18432, 0
    s_sub_u32 s75, s75, s88
    s_waitcnt vmcnt(4)
    ds_read_b64_tr_b16 v[144:145], v239
    ds_read_b64_tr_b16 v[146:147], v239 offset:1024
    ds_read_b64_tr_b16 v[148:149], v239 offset:256
    ds_read_b64_tr_b16 v[150:151], v239 offset:1280
    s_waitcnt lgkmcnt(0)
    s_mov_b32 m0, s61
    s_nop 0
    buffer_load_dwordx4 v241, s[76:79], s74 offen lds
    s_waitcnt vmcnt(4)
    v_mfma_f32_32x32x16_bf16 v[112:127], v[144:147], v[152:155], v[112:127]
    buffer_load_dwordx4 v228, s[76:79], s74 offen offset:1024 lds
    s_add_u32 s74, s74, 16384
    s_nop 0
    v_mfma_f32_32x32x16_bf16 v[128:143], v[148:151], v[152:155], v[128:143]
    buffer_load_dwordx4 v[152:155], v4, s[64:67], s75 offen offset:0 sc1
    s_waitcnt vmcnt(4)
    ds_read_b64_tr_b16 v[144:145], v240
    ds_read_b64_tr_b16 v[146:147], v240 offset:1024
    ds_read_b64_tr_b16 v[148:149], v240 offset:256
    ds_read_b64_tr_b16 v[150:151], v240 offset:1280
    s_waitcnt lgkmcnt(0)
    s_mov_b32 m0, s62
    s_nop 0
    buffer_load_dwordx4 v241, s[76:79], s74 offen lds
    s_waitcnt vmcnt(4)
    v_mfma_f32_32x32x16_bf16 v[112:127], v[144:147], v[156:159], v[112:127]
    buffer_load_dwordx4 v228, s[76:79], s74 offen offset:1024 lds
    s_add_u32 s74, s74, 16384
    s_cmp_eq_u32 s74, s44
    s_cselect_b32 s88, 294912, 0
    s_sub_u32 s74, s74, s88
    s_nop 0
    v_mfma_f32_32x32x16_bf16 v[128:143], v[148:151], v[156:159], v[128:143]
    buffer_load_dwordx4 v[156:159], v4, s[64:67], s75 offen offset:1024 sc1
    s_add_u32 s75, s75, 2048
    s_cmp_eq_u32 s75, s45
    s_cselect_b32 s88, 18432, 0
    s_sub_u32 s75, s75, s88
    s_waitcnt vmcnt(4)
    ds_read_b64_tr_b16 v[144:145], v239
    ds_read_b64_tr_b16 v[146:147], v239 offset:1024
    ds_read_b64_tr_b16 v[148:149], v239 offset:256
    ds_read_b64_tr_b16 v[150:151], v239 offset:1280
    s_waitcnt lgkmcnt(0)
    s_mov_b32 m0, s61
    s_nop 0
    buffer_load_dwordx4 v241, s[76:79], s74 offen lds
    s_waitcnt vmcnt(4)
    v_mfma_f32_32x32x16_bf16 v[112:127], v[144:147], v[152:155], v[112:127]
    buffer_load_dwordx4 v228, s[76:79], s74 offen offset:1024 lds
    s_add_u32 s74, s74, 16384
    s_nop 0
    v_mfma_f32_32x32x16_bf16 v[128:143], v[148:151], v[152:155], v[128:143]
    buffer_load_dwordx4 v[152:155], v4, s[64:67], s75 offen offset:0 sc1
    s_waitcnt vmcnt(4)
    ds_read_b64_tr_b16 v[144:145], v240
    ds_read_b64_tr_b16 v[146:147], v240 offset:1024
    ds_read_b64_tr_b16 v[148:149], v240 offset:256
    ds_read_b64_tr_b16 v[150:151], v240 offset:1280
    s_waitcnt lgkmcnt(0)
    s_mov_b32 m0, s62
    s_nop 0
    buffer_load_dwordx4 v241, s[76:79], s74 offen lds
    s_waitcnt vmcnt(4)
    v_mfma_f32_32x32x16_bf16 v[112:127], v[144:147], v[156:159], v[112:127]
    buffer_load_dwordx4 v228, s[76:79], s74 offen offset:1024 lds
    s_add_u32 s74, s74, 16384
    s_cmp_eq_u32 s74, s44
    s_cselect_b32 s88, 294912, 0
    s_sub_u32 s74, s74, s88
    s_nop 0
    v_mfma_f32_32x32x16_bf16 v[128:143], v[148:151], v[156:159], v[128:143]
    buffer_load_dwordx4 v[156:159], v4, s[64:67], s75 offen offset:1024 sc1
    s_add_u32 s75, s75, 2048
    s_cmp_eq_u32 s75, s45
    s_cselect_b32 s88, 18432, 0
    s_sub_u32 s75, s75, s88
    s_waitcnt vmcnt(4)
    ds_read_b64_tr_b16 v[144:145], v239
    ds_read_b64_tr_b16 v[146:147], v239 offset:1024
    ds_read_b64_tr_b16 v[148:149], v239 offset:256
    ds_read_b64_tr_b16 v[150:151], v239 offset:1280
    s_waitcnt lgkmcnt(0)
    s_mov_b32 m0, s61
    s_nop 0
    buffer_load_dwordx4 v241, s[76:79], s74 offen lds
    s_waitcnt vmcnt(4)
    v_mfma_f32_32x32x16_bf16 v[112:127], v[144:147], v[152:155], v[112:127]
    buffer_load_dwordx4 v228, s[76:79], s74 offen offset:1024 lds
    s_add_u32 s74, s74, 16384
    s_nop 0
    v_mfma_f32_32x32x16_bf16 v[128:143], v[148:151], v[152:155], v[128:143]
    buffer_load_dwordx4 v[152:155], v4, s[64:67], s75 offen offset:0 sc1
    s_waitcnt vmcnt(4)
    ds_read_b64_tr_b16 v[144:145], v240
    ds_read_b64_tr_b16 v[146:147], v240 offset:1024
    ds_read_b64_tr_b16 v[148:149], v240 offset:256
    ds_read_b64_tr_b16 v[150:151], v240 offset:1280
    s_waitcnt lgkmcnt(0)
    s_mov_b32 m0, s62
    s_nop 0
    buffer_load_dwordx4 v241, s[76:79], s74 offen lds
    s_waitcnt vmcnt(4)
    v_mfma_f32_32x32x16_bf16 v[112:127], v[144:147], v[156:159], v[112:127]
    buffer_load_dwordx4 v228, s[76:79], s74 offen offset:1024 lds
    s_add_u32 s74, s74, 16384
    s_cmp_eq_u32 s74, s44
    s_cselect_b32 s88, 294912, 0
    s_sub_u32 s74, s74, s88
    s_nop 0
    v_mfma_f32_32x32x16_bf16 v[128:143], v[148:151], v[156:159], v[128:143]
    buffer_load_dwordx4 v[156:159], v4, s[64:67], s75 offen offset:1024 sc1
    s_add_u32 s75, s75, 2048
    s_cmp_eq_u32 s75, s45
    s_cselect_b32 s88, 18432, 0
    s_sub_u32 s75, s75, s88
    s_waitcnt vmcnt(4)
    ds_read_b64_tr_b16 v[144:145], v239
    ds_read_b64_tr_b16 v[146:147], v239 offset:1024
    ds_read_b64_tr_b16 v[148:149], v239 offset:256
    ds_read_b64_tr_b16 v[150:151], v239 offset:1280
    s_waitcnt lgkmcnt(0)
    s_mov_b32 m0, s61
    s_nop 0
    buffer_load_dwordx4 v241, s[76:79], s74 offen lds
    s_waitcnt vmcnt(4)
    v_mfma_f32_32x32x16_bf16 v[112:127], v[144:147], v[152:155], v[112:127]
    buffer_load_dwordx4 v228, s[76:79], s74 offen offset:1024 lds
    s_add_u32 s74, s74, 16384
    s_nop 0
    v_mfma_f32_32x32x16_bf16 v[128:143], v[148:151], v[152:155], v[128:143]
    buffer_load_dwordx4 v[152:155], v4, s[64:67], s75 offen offset:0 sc1
    s_waitcnt vmcnt(4)
    ds_read_b64_tr_b16 v[144:145], v240
    ds_read_b64_tr_b16 v[146:147], v240 offset:1024
    ds_read_b64_tr_b16 v[148:149], v240 offset:256
    ds_read_b64_tr_b16 v[150:151], v240 offset:1280
    s_waitcnt lgkmcnt(0)
    s_mov_b32 m0, s62
    s_nop 0
    buffer_load_dwordx4 v241, s[76:79], s74 offen lds
    s_waitcnt vmcnt(4)
    v_mfma_f32_32x32x16_bf16 v[112:127], v[144:147], v[156:159], v[112:127]
    buffer_load_dwordx4 v228, s[76:79], s74 offen offset:1024 lds
    s_add_u32 s74, s74, 16384
    s_cmp_eq_u32 s74, s44
    s_cselect_b32 s88, 294912, 0
    s_sub_u32 s74, s74, s88
    s_nop 0
    v_mfma_f32_32x32x16_bf16 v[128:143], v[148:151], v[156:159], v[128:143]
    buffer_load_dwordx4 v[156:159], v4, s[64:67], s75 offen offset:1024 sc1
    s_add_u32 s75, s75, 2048
    s_cmp_eq_u32 s75, s45
    s_cselect_b32 s88, 18432, 0
    s_sub_u32 s75, s75, s88
    s_waitcnt vmcnt(4)
    ds_read_b64_tr_b16 v[144:145], v239
    ds_read_b64_tr_b16 v[146:147], v239 offset:1024
    ds_read_b64_tr_b16 v[148:149], v239 offset:256
    ds_read_b64_tr_b16 v[150:151], v239 offset:1280
    s_waitcnt lgkmcnt(0)
    s_mov_b32 m0, s61
    s_nop 0
    buffer_load_dwordx4 v241, s[76:79], s74 offen lds
    s_waitcnt vmcnt(4)
    v_mfma_f32_32x32x16_bf16 v[112:127], v[144:147], v[152:155], v[112:127]
    buffer_load_dwordx4 v228, s[76:79], s74 offen offset:1024 lds
    s_add_u32 s74, s74, 16384
    s_nop 0
    v_mfma_f32_32x32x16_bf16 v[128:143], v[148:151], v[152:155], v[128:143]
    buffer_load_dwordx4 v[152:155], v4, s[64:67], s75 offen offset:0 sc1
    s_waitcnt vmcnt(4)
    ds_read_b64_tr_b16 v[144:145], v240
    ds_read_b64_tr_b16 v[146:147], v240 offset:1024
    ds_read_b64_tr_b16 v[148:149], v240 offset:256
    ds_read_b64_tr_b16 v[150:151], v240 offset:1280
    s_waitcnt lgkmcnt(0)
    s_mov_b32 m0, s62
    s_nop 0
    buffer_load_dwordx4 v241, s[76:79], s74 offen lds
    s_waitcnt vmcnt(4)
    v_mfma_f32_32x32x16_bf16 v[112:127], v[144:147], v[156:159], v[112:127]
    buffer_load_dwordx4 v228, s[76:79], s74 offen offset:1024 lds
    s_add_u32 s74, s74, 16384
    s_cmp_eq_u32 s74, s44
    s_cselect_b32 s88, 294912, 0
    s_sub_u32 s74, s74, s88
    s_nop 0
    v_mfma_f32_32x32x16_bf16 v[128:143], v[148:151], v[156:159], v[128:143]
    buffer_load_dwordx4 v[204:207], v4, s[64:67], s75 offen offset:1024 sc1
    s_add_u32 s75, s75, 2048
    s_cmp_eq_u32 s75, s45
    s_cselect_b32 s88, 18432, 0
    s_sub_u32 s75, s75, s88
    s_waitcnt vmcnt(4)
    ds_read_b64_tr_b16 v[144:145], v239
    ds_read_b64_tr_b16 v[146:147], v239 offset:1024
    ds_read_b64_tr_b16 v[148:149], v239 offset:256
    ds_read_b64_tr_b16 v[150:151], v239 offset:1280
    s_waitcnt lgkmcnt(0)
    s_mov_b32 m0, s61
    s_nop 0
    buffer_load_dwordx4 v241, s[76:79], s74 offen lds
    s_waitcnt vmcnt(4)
    v_mfma_f32_32x32x16_bf16 v[112:127], v[144:147], v[152:155], v[112:127]
    buffer_load_dwordx4 v228, s[76:79], s74 offen offset:1024 lds
    s_add_u32 s74, s74, 16384
    s_nop 0
    v_mfma_f32_32x32x16_bf16 v[128:143], v[148:151], v[152:155], v[128:143]
    buffer_load_dwordx4 v[208:211], v4, s[64:67], s75 offen offset:0 sc1
    s_waitcnt vmcnt(4)
    ds_read_b64_tr_b16 v[180:181], v240
    ds_read_b64_tr_b16 v[182:183], v240 offset:1024
    ds_read_b64_tr_b16 v[184:185], v240 offset:256
    ds_read_b64_tr_b16 v[186:187], v240 offset:1280
    s_waitcnt lgkmcnt(0)
    s_mov_b32 m0, s62
    s_nop 0
    buffer_load_dwordx4 v241, s[76:79], s74 offen lds
    buffer_load_dwordx4 v228, s[76:79], s74 offen offset:1024 lds
    s_add_u32 s74, s74, 16384
    s_cmp_eq_u32 s74, s44
    s_cselect_b32 s88, 294912, 0
    s_sub_u32 s74, s74, s88
    s_nop 0
    buffer_load_dwordx4 v[212:215], v4, s[64:67], s75 offen offset:1024 sc1
    s_add_u32 s75, s75, 2048
    s_cmp_eq_u32 s75, s45
    s_cselect_b32 s88, 18432, 0
    s_sub_u32 s75, s75, s88
    s_waitcnt vmcnt(4)
    ds_read_b64_tr_b16 v[188:189], v239
    ds_read_b64_tr_b16 v[190:191], v239 offset:1024
    ds_read_b64_tr_b16 v[192:193], v239 offset:256
    ds_read_b64_tr_b16 v[194:195], v239 offset:1280
    s_waitcnt lgkmcnt(0)
    s_nop 0
    s_nop 0
    s_waitcnt vmcnt(1)
    ds_read_b64_tr_b16 v[196:197], v240
    ds_read_b64_tr_b16 v[198:199], v240 offset:1024
    ds_read_b64_tr_b16 v[200:201], v240 offset:256
    ds_read_b64_tr_b16 v[202:203], v240 offset:1280
    s_waitcnt lgkmcnt(0)
    s_nop 0
    s_bitcmp1_b32 s3, 0
    s_cselect_b32 s6, 8192, 0
    s_add_u32 s63, s63, s6
    s_add_u32 s74, s44, s6
    s_mov_b32 s75, s45
    s_lshr_b32 s6, s6, 3
    s_lshl_b32 s7, s60, 14
    s_add_u32 s61, s6, s7
    s_lshr_b32 s7, s7, 1
    s_add_u32 s62, s6, s7
    s_add_u32 s62, s62, 65536
    s_barrier
    s_or_b32 s6, s2, s3
    s_cmp_lg_u32 s6, 0
    s_cbranch_scc1 L_ep0s
    v_and_b32 v5, 7, v1
    v_mul_u32_u24 v6, 6, v5
    v_mul_u32_u24 v5, 5, v5
    v_add_u32 v5, 3, v5
    v_min_u32 v5, v5, v6
    v_lshrrev_b32 v6, 3, v1
    v_lshlrev_b32 v6, 9, v6
    v_lshl_add_u32 v5, v5, 2, v6
    s_mov_b32 s6, 532480
    buffer_load_dword v144, v5, s[20:23], s6 offen sc1
    s_mov_b32 s6, 536576
    buffer_load_dword v145, v5, s[20:23], s6 offen sc1
    s_mov_b32 s6, 540672
    buffer_load_dword v146, v5, s[20:23], s6 offen sc1
    s_mov_b32 s6, 544768
    buffer_load_dword v147, v5, s[20:23], s6 offen sc1
L_ep0s:
    s_add_u32 m0, s62, 0
    s_nop 0
    buffer_load_dwordx4 v241, s[76:79], s74 offen lds
    s_add_u32 s74, s74, 16384
    s_waitcnt lgkmcnt(0)
    s_add_u32 m0, s62, 2048
    s_nop 0
    buffer_load_dwordx4 v241, s[76:79], s74 offen lds
    s_add_u32 s74, s74, 16384
    s_add_u32 m0, s62, 4096
    s_nop 0
    buffer_load_dwordx4 v241, s[76:79], s74 offen lds
    s_add_u32 s74, s74, 16384
    buffer_load_dwordx4 v[164:167], v4, s[64:67], s75 offen offset:0 sc1
    s_waitcnt lgkmcnt(0)
    s_add_u32 m0, s62, 6144
    s_nop 0
    buffer_load_dwordx4 v241, s[76:79], s74 offen lds
    s_add_u32 s74, s74, 16384
    buffer_load_dwordx4 v[168:171], v4, s[64:67], s75 offen offset:1024 sc1
    s_or_b32 s6, s2, s3
    s_cmp_lg_u32 s6, 0
    s_cbranch_scc1 L_ep1s
    s_mov_b32 s7, 200000
    s_waitcnt vmcnt(6)
L_pes:
    v_xor_b32 v144, s56, v144
    v_xor_b32 v145, s56, v145
    v_xor_b32 v146, s56, v146
    v_xor_b32 v147, s56, v147
    v_or3_b32 v144, v144, v145, v146
    v_or_b32 v144, v144, v147
    v_cmp_ne_u32 vcc, 0, v144
    s_cbranch_vccz L_eoks
    s_sub_u32 s7, s7, 1
    s_cmp_eq_u32 s7, 0
    s_cbranch_scc1 L_eoks
    s_mov_b32 s6, 532480
    buffer_load_dword v144, v5, s[20:23], s6 offen sc1
    s_mov_b32 s6, 536576
    buffer_load_dword v145, v5, s[20:23], s6 offen sc1
    s_mov_b32 s6, 540672
    buffer_load_dword v146, v5, s[20:23], s6 offen sc1
    s_mov_b32 s6, 544768
    buffer_load_dword v147, v5, s[20:23], s6 offen sc1
    s_waitcnt vmcnt(0)
    s_branch L_pes
L_eoks:
    v_mov_b32 v5, s56
    v_mov_b32 v6, 0
    s_mov_b32 s6, 524288
    buffer_store_dword v5, v6, s[20:23], s6 offen sc1
L_ep1s:
    s_add_u32 m0, s61, 0
    s_nop 0
    buffer_load_dwordx4 v241, s[96:99], s63 offen lds
    s_add_u32 s63, s63, 16384
    buffer_load_dwordx4 v[172:175], v4, s[64:67], s75 offen offset:2048 sc1
    s_waitcnt lgkmcnt(0)
    s_add_u32 m0, s61, 2048
    s_nop 0
    buffer_load_dwordx4 v241, s[96:99], s63 offen lds
    s_add_u32 s63, s63, 16384
    buffer_load_dwordx4 v[176:179], v4, s[64:67], s75 offen offset:3072 sc1
    s_add_u32 m0, s61, 4096
    s_nop 0
    buffer_load_dwordx4 v241, s[96:99], s63 offen lds
    s_add_u32 s63, s63, 16384
    s_waitcnt lgkmcnt(0)
    s_add_u32 m0, s61, 6144
    s_nop 0
    buffer_load_dwordx4 v241, s[96:99], s63 offen lds
    s_add_u32 s63, s63, 16384
    s_add_u32 m0, s61, 8192
    s_nop 0
    buffer_load_dwordx4 v241, s[96:99], s63 offen lds
    s_add_u32 s63, s63, 16384
    s_waitcnt lgkmcnt(0)
    s_add_u32 m0, s61, 10240
    s_nop 0
    buffer_load_dwordx4 v241, s[96:99], s63 offen lds
    s_add_u32 s63, s63, 16384
    s_add_u32 m0, s61, 12288
    s_nop 0
    buffer_load_dwordx4 v241, s[96:99], s63 offen lds
    s_add_u32 s63, s63, 16384
    s_waitcnt lgkmcnt(0)
    s_add_u32 m0, s61, 14336
    s_nop 0
    buffer_load_dwordx4 v241, s[96:99], s63 offen lds
    s_add_u32 s63, s63, 16384
    s_nop 0
    s_waitcnt lgkmcnt(0)
    s_nop 0
    s_xor_b32 s6, s3, 4
    s_mul_i32 s6, s6, 3072
    s_add_u32 s6, s6, 135168
    v_add_u32 v2, s6, v4
    s_mul_i32 s6, s3, 3072
    s_add_u32 s6, s6, 135168
    v_add_u32 v3, s6, v4
    v_cmp_lt_u32 vcc, 31, v1
    s_cmp_eq_u32 s87, 0
    s_cbranch_scc0 L_sc1
    v_cndmask_b32 v104, v104, v108, vcc
    v_mov_b32 v105, v29
    ds_write_b128 v2, v[96:99]
    ds_write_b128 v2, v[100:103] offset:1024
    ds_write_b128 v2, v[104:107] offset:2048
    v_cndmask_b32 v88, v88, v92, vcc
    s_branch L_sc2
L_sc1:
    v_cndmask_b32 v88, v88, v92, vcc
    v_mov_b32 v89, v28
    ds_write_b128 v2, v[80:83]
    ds_write_b128 v2, v[84:87] offset:1024
    ds_write_b128 v2, v[88:91] offset:2048
    v_cndmask_b32 v88, v104, v108, vcc
    v_mov_b64 v[80:81], v[96:97]
    v_mov_b64 v[82:83], v[98:99]
    v_mov_b64 v[84:85], v[100:101]
    v_mov_b64 v[86:87], v[102:103]
    v_mov_b32 v28, v29
L_sc2:
    s_waitcnt vmcnt(0) lgkmcnt(0)
    s_barrier
    ds_read_b128 v[48:51], v3
    ds_read_b128 v[52:55], v3 offset:1024
    ds_read_b64 v[56:57], v3 offset:2048
    s_waitcnt lgkmcnt(0)
    v_max_f32 v5, v28, v57
    v_sub_f32 v28, v28, v5
    v_sub_f32 v29, v57, v5
    v_exp_f32 v28, v28
    v_exp_f32 v29, v29
    s_nop 0
    v_mul_f32 v80, v80, v28
    v_mul_f32 v81, v81, v28
    v_mul_f32 v82, v82, v28
    v_mul_f32 v83, v83, v28
    v_mul_f32 v84, v84, v28
    v_mul_f32 v85, v85, v28
    v_mul_f32 v86, v86, v28
    v_mul_f32 v87, v87, v28
    v_mul_f32 v88, v88, v28
    v_fmac_f32 v80, v48, v29
    v_fmac_f32 v81, v49, v29
    v_fmac_f32 v82, v50, v29
    v_fmac_f32 v83, v51, v29
    v_fmac_f32 v84, v52, v29
    v_fmac_f32 v85, v53, v29
    v_fmac_f32 v86, v54, v29
    v_fmac_f32 v87, v55, v29
    v_fmac_f32 v88, v56, v29
    v_mov_b32 v5, v88
    s_branch L_fin
.section .rodata,"a"
.p2align 6
.amdhsa_kernel parallel_sum__grouped_kv_mqa__dense_activation_mish__prompt_kernel
.amdhsa_next_free_vgpr 248
.amdhsa_next_free_sgpr 102
.amdhsa_accum_offset 248
.amdhsa_group_segment_fixed_size 0
.amdhsa_kernarg_size 96
.amdhsa_user_sgpr_count 2
.amdhsa_user_sgpr_kernarg_segment_ptr 1
.amdhsa_system_sgpr_workgroup_id_x 1
.end_amdhsa_kernel
```
